```python
import torch

def _softmax(x, axis=-1):
    return torch.softmax(x, dim=axis)
def _gelu(x):
    return torch.nn.functional.gelu(x, approximate="tanh")
def _silu(x):
    return torch.nn.functional.silu(x)
def _sigmoid(x):
    return torch.sigmoid(x)
def _layernorm(x, axis=-1, eps=1e-5):
    m = x.mean(dim=axis, keepdim=True)
    v = x.var(dim=axis, keepdim=True, unbiased=False)
    return (x - m) / torch.sqrt(v + eps)
def _scatter_add(tgt, idx, src, axis=0):
    return tgt.clone().index_add_(axis, idx, src)
def _segment_sum(src, seg, n):
    out = torch.zeros((n,) + src.shape[1:], dtype=src.dtype)
    return out.index_add_(0, seg, src)
def _pad(x, pw):
    flat = tuple(v for pair in reversed(pw) for v in pair)
    return torch.nn.functional.pad(x, flat)

kernel_name = 'standalone__weight_only_int_quip__prompt'

def setup_inputs():

    _w = (lambda a: (lambda t: t.to(torch.bfloat16) if t.is_floating_point() else t)(torch.as_tensor(a)))
    B, S, D, F = 1, 2048, 512, 1376
    G = 128 if 128 > 0 else D
    D = (D // G) * G
    ng = D // G
    bits = 4 if 4 > 0 else 4
    qmax = 1 << bits
    qw = torch.randint(0, qmax, (D, F)).to(torch.int32)
    U, _ = (lambda *_a, **_k: torch.linalg.qr(*[torch.as_tensor(_x).float() for _x in _a], **_k))((lambda *s: torch.randn(*s, dtype=torch.bfloat16) * 0.05)(D, D))
    V, _ = (lambda *_a, **_k: torch.linalg.qr(*[torch.as_tensor(_x).float() for _x in _a], **_k))((lambda *s: torch.randn(*s, dtype=torch.bfloat16) * 0.05)(F, F))
    return {
        "x": _w((lambda *s: torch.randn(*s, dtype=torch.bfloat16) * 0.05)(B, S, D)),
        "qw": _w(qw),
        "scales": _w(torch.abs((lambda *s: torch.randn(*s, dtype=torch.bfloat16) * 0.05)(ng, F)) * 0.02 + 0.005),
        "zeros": _w(torch.full((ng, F), qmax / 2.0, dtype=float)),
        "U": _w(U.to(float)),
        "V": _w(V.to(float)),
    }

def reference(x, qw, scales, zeros, U, V):
    B, S, D = x.shape
    ng, F = scales.shape
    G = D // ng
    s = (lambda x, n, axis: torch.repeat_interleave(x, n, dim=axis))(scales, G, axis=0)
    z = (lambda x, n, axis: torch.repeat_interleave(x, n, dim=axis))(zeros, G, axis=0)
    wq = ((lambda x, dt: x.to(dt))(qw, x.dtype) - z) * s
    xr = torch.einsum("bsd,de->bse", x, U)
    h  = torch.einsum("bse,ef->bsf", xr, wq)
    y  = torch.einsum("bsf,fg->bsg", h, V)
    return y
```

```asm
; @launch grid=(256,1,1) block=(256,1,1) lds=163840
.amdgcn_target "amdgcn-amd-amdhsa--gfx950"
.text
.globl standalone__weight_only_int_quip__prompt_kernel
.p2align 8
.type standalone__weight_only_int_quip__prompt_kernel,@function
standalone__weight_only_int_quip__prompt_kernel:
  s_cmp_ge_u32 s2, 256
  s_cbranch_scc1 K_end
  s_load_dwordx2 s[12:13], s[0:1], 8
  s_load_dwordx2 s[16:17], s[0:1], 16
  s_load_dwordx2 s[20:21], s[0:1], 24
  s_load_dwordx2 s[24:25], s[0:1], 32
  s_load_dwordx2 s[8:9], s[0:1], 0
  s_load_dwordx2 s[28:29], s[0:1], 40
  s_load_dwordx2 s[32:33], s[0:1], 48
  s_load_dwordx2 s[52:53], s[0:1], 56
  s_load_dwordx2 s[92:93], s[0:1], 64
  v_lshrrev_b32 v1, 6, v0
  v_and_b32 v0, 63, v0
  v_readfirstlane_b32 s56, v1
  s_mov_b32 s14, 2818048
  s_mov_b32 s15, 0x20000
  s_mov_b32 s18, 11008
  s_mov_b32 s19, 0x20000
  s_mov_b32 s22, 11008
  s_mov_b32 s23, 0x20000
  s_mov_b32 s26, 524288
  s_mov_b32 s27, 0x20000
  s_mov_b32 s10, 2097152
  s_mov_b32 s11, 0x20000
  s_mov_b32 s30, 3786752
  s_mov_b32 s31, 0x20000
  s_mov_b32 s34, 5636096
  s_mov_b32 s35, 0x20000
  s_mov_b32 s54, 256
  s_mov_b32 s55, 0x20000
  s_mov_b32 s38, 1441792
  s_mov_b32 s39, 0x20000
  s_mov_b32 s42, 2097152
  s_mov_b32 s43, 0x20000
  s_mov_b32 s46, 1409024
  s_mov_b32 s47, 0x20000
  s_mov_b32 s50, 16384
  s_mov_b32 s51, 0x20000
  s_cmp_eq_u32 s2, 250
  s_cbranch_scc0 K_np
  s_cmp_eq_u32 s56, 0
  s_cbranch_scc0 K_np
  s_waitcnt lgkmcnt(0)
  s_memrealtime s[62:63]
  s_waitcnt lgkmcnt(0)
  s_or_b32 s62, s62, 1
  v_mov_b32 v2, s62
  s_mov_b64 exec, 1
  buffer_store_dword v2, off, s[52:55], 0 sc1
  s_mov_b64 exec, -1
K_np:
  s_cmp_eq_u32 s56, 3
  s_cbranch_scc0 K_ncpf
  s_getpc_b64 s[62:63]
K_pc:
  s_sub_u32 s62, s62, K_pc-standalone__weight_only_int_quip__prompt_kernel
  s_subb_u32 s63, s63, 0
  s_mov_b32 s64, K_code_end-standalone__weight_only_int_quip__prompt_kernel-4
  v_lshlrev_b32 v2, 7, v0
  v_add_u32 v3, 0, v2
  v_min_u32 v3, s64, v3
  global_load_dword v255, v3, s[62:63]
  v_add_u32 v3, 8192, v2
  v_min_u32 v3, s64, v3
  global_load_dword v255, v3, s[62:63]
  v_add_u32 v3, 16384, v2
  v_min_u32 v3, s64, v3
  global_load_dword v255, v3, s[62:63]
  v_add_u32 v3, 24576, v2
  v_min_u32 v3, s64, v3
  global_load_dword v255, v3, s[62:63]
K_ncpf:
  s_and_b32 s62, s2, 7
  s_lshr_b32 s63, s2, 3
  s_and_b32 s64, s62, 3
  s_lshl_b32 s64, s64, 2
  s_and_b32 s65, s63, 3
  s_add_u32 s60, s64, s65
  s_lshr_b32 s64, s62, 2
  s_lshl_b32 s64, s64, 3
  s_lshr_b32 s65, s63, 2
  s_add_u32 s61, s64, s65
  s_lshr_b32 s64, s62, 1
  s_and_b32 s65, s64, 1
  s_sub_u32 s65, 6, s65
  s_lshl_b32 s65, s65, 2
  s_cmp_lt_u32 s63, s65
  s_cbranch_scc0 K_notT
  s_and_b32 s66, s62, 1
  s_lshl_b32 s66, s66, 2
  s_and_b32 s67, s63, 3
  s_add_u32 s58, s66, s67
  s_mul_i32 s64, s64, 11
  s_add_u32 s64, s64, 1
  s_lshr_b32 s64, s64, 1
  s_lshr_b32 s66, s63, 2
  s_add_u32 s59, s64, s66
  s_mul_i32 s67, s67, 11
  s_lshr_b32 s67, s67, 2
  s_lshl_b32 s66, s66, 1
  s_add_u32 s94, s67, s66
  s_and_b32 s66, s62, 1
  s_mul_i32 s66, s66, 5
  s_add_u32 s94, s94, s66
  v_lshrrev_b32 v1, 3, v0
  v_and_b32 v2, 7, v0
  v_bfe_u32 v3, v1, 1, 1
  v_lshlrev_b32 v3, 2, v3
  v_xor_b32 v2, v2, v3
  v_mul_u32_u24 v10, 2752, v1
  v_lshl_add_u32 v10, v2, 4, v10
  s_mul_i32 s73, s56, 11
  s_add_u32 s69, s94, s73
  s_lshl_b32 s70, s59, 7
  s_mul_i32 s71, s56, 40960
  s_lshl_b32 s68, s58, 2
  s_add_u32 s68, s68, s56
  v_lshrrev_b32 v161, 3, v0
  v_and_b32 v162, 7, v0
  v_mul_u32_u24 v163, 5504, v161
  v_lshl_add_u32 v163, v162, 4, v163
  v_lshlrev_b32 v164, 3, v162
  s_cmp_eq_u32 s59, 21
  s_cselect_b32 s62, 0x40000000, 128
  s_cselect_b32 s63, 0x40000000, 64
  v_add_u32 v165, s62, v163
  v_add_u32 v166, s63, v164
  s_mul_i32 s64, s68, 88064
  s_lshl_b32 s65, s59, 8
  s_add_u32 s64, s64, s65
  s_add_u32 s65, s64, 44032
  s_lshr_b32 s66, s68, 3
  s_mul_i32 s66, s66, 2752
  s_lshl_b32 s67, s59, 7
  s_add_u32 s66, s66, s67
  s_waitcnt lgkmcnt(0)
  buffer_load_dwordx4 v[168:171], v163, s[12:15], s64 offen
  buffer_load_dwordx4 v[172:175], v165, s[12:15], s64 offen
  buffer_load_dwordx4 v[176:179], v163, s[12:15], s65 offen
  buffer_load_dwordx4 v[180:183], v165, s[12:15], s65 offen
  buffer_load_dwordx2 v[184:185], v164, s[16:19], s66 offen
  buffer_load_dwordx2 v[186:187], v166, s[16:19], s66 offen
  buffer_load_dwordx2 v[188:189], v164, s[20:23], s66 offen
  buffer_load_dwordx2 v[190:191], v166, s[20:23], s66 offen
  s_add_u32 s36, s92, 0
  s_addc_u32 s37, s93, 0
  s_add_u32 s48, s92, 6291456
  s_addc_u32 s49, s93, 0
  s_add_u32 s40, s92, 2097152
  s_addc_u32 s41, s93, 0
  s_add_u32 s44, s92, 4194304
  s_addc_u32 s45, s93, 0
  v_lshrrev_b32 v167, 2, v162
  v_lshlrev_b32 v167, 10, v167
  v_and_b32 v192, 3, v162
  v_lshl_add_u32 v167, v192, 8, v167
  v_lshl_add_u32 v167, v161, 4, v167
  v_lshrrev_b32 v1, 4, v0
  v_bfe_u32 v2, v0, 2, 2
  v_and_b32 v3, 3, v0
  v_lshl_add_u32 v4, v1, 2, v2
  v_lshlrev_b32 v4, 7, v4
  v_lshl_add_u32 v4, v3, 4, v4
  v_lshrrev_b32 v5, 1, v2
  v_lshl_add_u32 v4, v5, 6, v4
  v_add_u32 v11, s71, v4
  v_xor_b32 v12, 64, v11
  v_lshlrev_b32 v13, 4, v0
  v_lshlrev_b32 v14, 2, v0
  v_add_u32 v15, 64, v0
  v_min_u32 v15, 87, v15
  v_lshlrev_b32 v15, 2, v15
  s_waitcnt vmcnt(0)
  buffer_load_dword v9, off, s[52:55], 0 sc1
  s_mul_i32 s62, s68, 44
  s_lshl_b32 s63, s59, 1
  s_add_u32 s62, s62, s63
  s_lshl_b32 s62, s62, 10
  s_mov_b32 s63, 0xffff0000
  v_lshlrev_b32 v192, 16, v184
  v_and_b32 v193, s63, v184
  v_lshlrev_b32 v200, 16, v188
  v_and_b32 v201, s63, v188
  v_lshlrev_b32 v194, 16, v185
  v_and_b32 v195, s63, v185
  v_lshlrev_b32 v202, 16, v189
  v_and_b32 v203, s63, v189
  v_lshlrev_b32 v196, 16, v186
  v_and_b32 v197, s63, v186
  v_lshlrev_b32 v204, 16, v190
  v_and_b32 v205, s63, v190
  v_lshlrev_b32 v198, 16, v187
  v_and_b32 v199, s63, v187
  v_lshlrev_b32 v206, 16, v191
  v_and_b32 v207, s63, v191
  v_cvt_f32_i32 v168, v168
  v_cvt_f32_i32 v169, v169
  v_cvt_f32_i32 v170, v170
  v_cvt_f32_i32 v171, v171
  v_cvt_f32_i32 v172, v172
  v_cvt_f32_i32 v173, v173
  v_cvt_f32_i32 v174, v174
  v_cvt_f32_i32 v175, v175
  v_sub_f32 v168, v168, v200
  v_sub_f32 v169, v169, v201
  v_sub_f32 v170, v170, v202
  v_sub_f32 v171, v171, v203
  v_sub_f32 v172, v172, v204
  v_sub_f32 v173, v173, v205
  v_sub_f32 v174, v174, v206
  v_sub_f32 v175, v175, v207
  v_cvt_pk_bf16_f32 v208, v168, v169
  v_cvt_pk_bf16_f32 v209, v170, v171
  v_cvt_pk_bf16_f32 v210, v172, v173
  v_cvt_pk_bf16_f32 v211, v174, v175
  v_lshlrev_b32 v168, 16, v208
  v_and_b32 v169, s63, v208
  v_lshlrev_b32 v170, 16, v209
  v_and_b32 v171, s63, v209
  v_lshlrev_b32 v172, 16, v210
  v_and_b32 v173, s63, v210
  v_lshlrev_b32 v174, 16, v211
  v_and_b32 v175, s63, v211
  v_mul_f32 v168, v168, v192
  v_mul_f32 v169, v169, v193
  v_mul_f32 v170, v170, v194
  v_mul_f32 v171, v171, v195
  v_mul_f32 v172, v172, v196
  v_mul_f32 v173, v173, v197
  v_mul_f32 v174, v174, v198
  v_mul_f32 v175, v175, v199
  v_cvt_pk_bf16_f32 v212, v168, v169
  v_cvt_pk_bf16_f32 v213, v170, v171
  v_cvt_pk_bf16_f32 v214, v172, v173
  v_cvt_pk_bf16_f32 v215, v174, v175
  buffer_store_dwordx4 v[212:215], v167, s[36:39], s62 offen offset:0 sc1
  v_cvt_f32_i32 v176, v176
  v_cvt_f32_i32 v177, v177
  v_cvt_f32_i32 v178, v178
  v_cvt_f32_i32 v179, v179
  v_cvt_f32_i32 v180, v180
  v_cvt_f32_i32 v181, v181
  v_cvt_f32_i32 v182, v182
  v_cvt_f32_i32 v183, v183
  v_sub_f32 v176, v176, v200
  v_sub_f32 v177, v177, v201
  v_sub_f32 v178, v178, v202
  v_sub_f32 v179, v179, v203
  v_sub_f32 v180, v180, v204
  v_sub_f32 v181, v181, v205
  v_sub_f32 v182, v182, v206
  v_sub_f32 v183, v183, v207
  v_cvt_pk_bf16_f32 v208, v176, v177
  v_cvt_pk_bf16_f32 v209, v178, v179
  v_cvt_pk_bf16_f32 v210, v180, v181
  v_cvt_pk_bf16_f32 v211, v182, v183
  v_lshlrev_b32 v176, 16, v208
  v_and_b32 v177, s63, v208
  v_lshlrev_b32 v178, 16, v209
  v_and_b32 v179, s63, v209
  v_lshlrev_b32 v180, 16, v210
  v_and_b32 v181, s63, v210
  v_lshlrev_b32 v182, 16, v211
  v_and_b32 v183, s63, v211
  v_mul_f32 v176, v176, v192
  v_mul_f32 v177, v177, v193
  v_mul_f32 v178, v178, v194
  v_mul_f32 v179, v179, v195
  v_mul_f32 v180, v180, v196
  v_mul_f32 v181, v181, v197
  v_mul_f32 v182, v182, v198
  v_mul_f32 v183, v183, v199
  v_cvt_pk_bf16_f32 v216, v176, v177
  v_cvt_pk_bf16_f32 v217, v178, v179
  v_cvt_pk_bf16_f32 v218, v180, v181
  v_cvt_pk_bf16_f32 v219, v182, v183
  buffer_store_dwordx4 v[216:219], v167, s[36:39], s62 offen offset:128 sc1
  s_add_u32 s73, s69, 0
  s_cmp_ge_u32 s73, 44
  s_cselect_b32 s75, 44, 0
  s_sub_u32 s73, s73, s75
  s_lshr_b32 s74, s73, 1
  s_lshl_b32 s74, s74, 6
  s_and_b32 s73, s73, 1
  s_lshl_b32 s73, s73, 4
  s_add_u32 s73, s73, s74
  s_mul_i32 s73, s73, 2752
  s_add_u32 s73, s73, s70
  s_add_u32 m0, s71, 0
  s_add_u32 s74, s73, 0
  buffer_load_dwordx4 v10, s[28:31], s74 offen lds
  s_add_u32 m0, s71, 1024
  s_add_u32 s74, s73, 22016
  buffer_load_dwordx4 v10, s[28:31], s74 offen lds
  s_add_u32 m0, s71, 2048
  s_add_u32 s74, s73, 88064
  buffer_load_dwordx4 v10, s[28:31], s74 offen lds
  s_add_u32 m0, s71, 3072
  s_add_u32 s74, s73, 110080
  buffer_load_dwordx4 v10, s[28:31], s74 offen lds
  s_add_u32 s73, s69, 1
  s_cmp_ge_u32 s73, 44
  s_cselect_b32 s75, 44, 0
  s_sub_u32 s73, s73, s75
  s_lshr_b32 s74, s73, 1
  s_lshl_b32 s74, s74, 6
  s_and_b32 s73, s73, 1
  s_lshl_b32 s73, s73, 4
  s_add_u32 s73, s73, s74
  s_mul_i32 s73, s73, 2752
  s_add_u32 s73, s73, s70
  s_add_u32 m0, s71, 4096
  s_add_u32 s74, s73, 0
  buffer_load_dwordx4 v10, s[28:31], s74 offen lds
  s_add_u32 m0, s71, 5120
  s_add_u32 s74, s73, 22016
  buffer_load_dwordx4 v10, s[28:31], s74 offen lds
  s_add_u32 m0, s71, 6144
  s_add_u32 s74, s73, 88064
  buffer_load_dwordx4 v10, s[28:31], s74 offen lds
  s_add_u32 m0, s71, 7168
  s_add_u32 s74, s73, 110080
  buffer_load_dwordx4 v10, s[28:31], s74 offen lds
  s_add_u32 s73, s69, 2
  s_cmp_ge_u32 s73, 44
  s_cselect_b32 s75, 44, 0
  s_sub_u32 s73, s73, s75
  s_lshr_b32 s74, s73, 1
  s_lshl_b32 s74, s74, 6
  s_and_b32 s73, s73, 1
  s_lshl_b32 s73, s73, 4
  s_add_u32 s73, s73, s74
  s_mul_i32 s73, s73, 2752
  s_add_u32 s73, s73, s70
  s_add_u32 m0, s71, 8192
  s_add_u32 s74, s73, 0
  buffer_load_dwordx4 v10, s[28:31], s74 offen lds
  s_add_u32 m0, s71, 9216
  s_add_u32 s74, s73, 22016
  buffer_load_dwordx4 v10, s[28:31], s74 offen lds
  s_add_u32 m0, s71, 10240
  s_add_u32 s74, s73, 88064
  buffer_load_dwordx4 v10, s[28:31], s74 offen lds
  s_add_u32 m0, s71, 11264
  s_add_u32 s74, s73, 110080
  buffer_load_dwordx4 v10, s[28:31], s74 offen lds
  s_waitcnt vmcnt(12)
  v_readfirstlane_b32 s57, v9
  s_mov_b32 s62, 200000
NC_1:
  s_cmp_lg_u32 s57, 0
  s_cbranch_scc1 ND_2
  s_sub_u32 s62, s62, 1
  s_cbranch_scc1 ND_2
  s_sleep 2
  buffer_load_dword v9, off, s[52:55], 0 sc1
  s_waitcnt vmcnt(0)
  v_readfirstlane_b32 s57, v9
  s_branch NC_1
ND_2:
  s_lshl_b32 s73, s58, 9
  s_lshl_b32 s74, s59, 4
  s_add_u32 s73, s73, s74
  s_lshl_b32 s74, s56, 2
  s_add_u32 s73, s73, s74
  s_add_u32 s73, s73, 0
  v_mov_b32 v2, s57
  s_mov_b64 exec, 1
  buffer_store_dword v2, off, s[48:51], s73 sc1
  s_mov_b64 exec, -1
  s_add_u32 s73, s69, 3
  s_cmp_ge_u32 s73, 44
  s_cselect_b32 s75, 44, 0
  s_sub_u32 s73, s73, s75
  s_lshr_b32 s74, s73, 1
  s_lshl_b32 s74, s74, 6
  s_and_b32 s73, s73, 1
  s_lshl_b32 s73, s73, 4
  s_add_u32 s73, s73, s74
  s_mul_i32 s73, s73, 2752
  s_add_u32 s73, s73, s70
  s_add_u32 m0, s71, 12288
  s_add_u32 s74, s73, 0
  buffer_load_dwordx4 v10, s[28:31], s74 offen lds
  s_add_u32 m0, s71, 13312
  s_add_u32 s74, s73, 22016
  buffer_load_dwordx4 v10, s[28:31], s74 offen lds
  s_add_u32 m0, s71, 14336
  s_add_u32 s74, s73, 88064
  buffer_load_dwordx4 v10, s[28:31], s74 offen lds
  s_add_u32 m0, s71, 15360
  s_add_u32 s74, s73, 110080
  buffer_load_dwordx4 v10, s[28:31], s74 offen lds
  s_add_u32 s73, s69, 4
  s_cmp_ge_u32 s73, 44
  s_cselect_b32 s75, 44, 0
  s_sub_u32 s73, s73, s75
  s_lshr_b32 s74, s73, 1
  s_lshl_b32 s74, s74, 6
  s_and_b32 s73, s73, 1
  s_lshl_b32 s73, s73, 4
  s_add_u32 s73, s73, s74
  s_mul_i32 s73, s73, 2752
  s_add_u32 s73, s73, s70
  s_add_u32 m0, s71, 16384
  s_add_u32 s74, s73, 0
  buffer_load_dwordx4 v10, s[28:31], s74 offen lds
  s_add_u32 m0, s71, 17408
  s_add_u32 s74, s73, 22016
  buffer_load_dwordx4 v10, s[28:31], s74 offen lds
  s_add_u32 m0, s71, 18432
  s_add_u32 s74, s73, 88064
  buffer_load_dwordx4 v10, s[28:31], s74 offen lds
  s_add_u32 m0, s71, 19456
  s_add_u32 s74, s73, 110080
  buffer_load_dwordx4 v10, s[28:31], s74 offen lds
  s_add_u32 s73, s69, 5
  s_cmp_ge_u32 s73, 44
  s_cselect_b32 s75, 44, 0
  s_sub_u32 s73, s73, s75
  s_lshr_b32 s74, s73, 1
  s_lshl_b32 s74, s74, 6
  s_and_b32 s73, s73, 1
  s_lshl_b32 s73, s73, 4
  s_add_u32 s73, s73, s74
  s_mul_i32 s73, s73, 2752
  s_add_u32 s73, s73, s70
  s_add_u32 m0, s71, 20480
  s_add_u32 s74, s73, 0
  buffer_load_dwordx4 v10, s[28:31], s74 offen lds
  s_add_u32 m0, s71, 21504
  s_add_u32 s74, s73, 22016
  buffer_load_dwordx4 v10, s[28:31], s74 offen lds
  s_add_u32 m0, s71, 22528
  s_add_u32 s74, s73, 88064
  buffer_load_dwordx4 v10, s[28:31], s74 offen lds
  s_add_u32 m0, s71, 23552
  s_add_u32 s74, s73, 110080
  buffer_load_dwordx4 v10, s[28:31], s74 offen lds
  s_add_u32 s73, s69, 6
  s_cmp_ge_u32 s73, 44
  s_cselect_b32 s75, 44, 0
  s_sub_u32 s73, s73, s75
  s_lshr_b32 s74, s73, 1
  s_lshl_b32 s74, s74, 6
  s_and_b32 s73, s73, 1
  s_lshl_b32 s73, s73, 4
  s_add_u32 s73, s73, s74
  s_mul_i32 s73, s73, 2752
  s_add_u32 s73, s73, s70
  s_add_u32 m0, s71, 24576
  s_add_u32 s74, s73, 0
  buffer_load_dwordx4 v10, s[28:31], s74 offen lds
  s_add_u32 m0, s71, 25600
  s_add_u32 s74, s73, 22016
  buffer_load_dwordx4 v10, s[28:31], s74 offen lds
  s_add_u32 m0, s71, 26624
  s_add_u32 s74, s73, 88064
  buffer_load_dwordx4 v10, s[28:31], s74 offen lds
  s_add_u32 m0, s71, 27648
  s_add_u32 s74, s73, 110080
  buffer_load_dwordx4 v10, s[28:31], s74 offen lds
  s_add_u32 s73, s69, 7
  s_cmp_ge_u32 s73, 44
  s_cselect_b32 s75, 44, 0
  s_sub_u32 s73, s73, s75
  s_lshr_b32 s74, s73, 1
  s_lshl_b32 s74, s74, 6
  s_and_b32 s73, s73, 1
  s_lshl_b32 s73, s73, 4
  s_add_u32 s73, s73, s74
  s_mul_i32 s73, s73, 2752
  s_add_u32 s73, s73, s70
  s_add_u32 m0, s71, 28672
  s_add_u32 s74, s73, 0
  buffer_load_dwordx4 v10, s[28:31], s74 offen lds
  s_add_u32 m0, s71, 29696
  s_add_u32 s74, s73, 22016
  buffer_load_dwordx4 v10, s[28:31], s74 offen lds
  s_add_u32 m0, s71, 30720
  s_add_u32 s74, s73, 88064
  buffer_load_dwordx4 v10, s[28:31], s74 offen lds
  s_add_u32 m0, s71, 31744
  s_add_u32 s74, s73, 110080
  buffer_load_dwordx4 v10, s[28:31], s74 offen lds
  s_add_u32 s73, s69, 8
  s_cmp_ge_u32 s73, 44
  s_cselect_b32 s75, 44, 0
  s_sub_u32 s73, s73, s75
  s_lshr_b32 s74, s73, 1
  s_lshl_b32 s74, s74, 6
  s_and_b32 s73, s73, 1
  s_lshl_b32 s73, s73, 4
  s_add_u32 s73, s73, s74
  s_mul_i32 s73, s73, 2752
  s_add_u32 s73, s73, s70
  s_add_u32 m0, s71, 32768
  s_add_u32 s74, s73, 0
  buffer_load_dwordx4 v10, s[28:31], s74 offen lds
  s_add_u32 m0, s71, 33792
  s_add_u32 s74, s73, 22016
  buffer_load_dwordx4 v10, s[28:31], s74 offen lds
  s_add_u32 m0, s71, 34816
  s_add_u32 s74, s73, 88064
  buffer_load_dwordx4 v10, s[28:31], s74 offen lds
  s_add_u32 m0, s71, 35840
  s_add_u32 s74, s73, 110080
  buffer_load_dwordx4 v10, s[28:31], s74 offen lds
  s_add_u32 s73, s69, 9
  s_cmp_ge_u32 s73, 44
  s_cselect_b32 s75, 44, 0
  s_sub_u32 s73, s73, s75
  s_lshr_b32 s74, s73, 1
  s_lshl_b32 s74, s74, 6
  s_and_b32 s73, s73, 1
  s_lshl_b32 s73, s73, 4
  s_add_u32 s73, s73, s74
  s_mul_i32 s73, s73, 2752
  s_add_u32 s73, s73, s70
  s_add_u32 m0, s71, 36864
  s_add_u32 s74, s73, 0
  buffer_load_dwordx4 v10, s[28:31], s74 offen lds
  s_add_u32 m0, s71, 37888
  s_add_u32 s74, s73, 22016
  buffer_load_dwordx4 v10, s[28:31], s74 offen lds
  s_add_u32 m0, s71, 38912
  s_add_u32 s74, s73, 88064
  buffer_load_dwordx4 v10, s[28:31], s74 offen lds
  s_add_u32 m0, s71, 39936
  s_add_u32 s74, s73, 110080
  buffer_load_dwordx4 v10, s[28:31], s74 offen lds
  s_waitcnt vmcnt(37)
  ds_read_b64_tr_b16 a[0:1], v11 offset:0
  ds_read_b64_tr_b16 a[2:3], v11 offset:2048
  ds_read_b64_tr_b16 a[4:5], v11 offset:8
  ds_read_b64_tr_b16 a[6:7], v11 offset:2056
  ds_read_b64_tr_b16 a[8:9], v12 offset:0
  ds_read_b64_tr_b16 a[10:11], v12 offset:2048
  ds_read_b64_tr_b16 a[12:13], v12 offset:8
  ds_read_b64_tr_b16 a[14:15], v12 offset:2056
  s_waitcnt lgkmcnt(0)
  s_add_u32 s73, s69, 10
  s_cmp_ge_u32 s73, 44
  s_cselect_b32 s75, 44, 0
  s_sub_u32 s73, s73, s75
  s_lshr_b32 s74, s73, 1
  s_lshl_b32 s74, s74, 6
  s_and_b32 s73, s73, 1
  s_lshl_b32 s73, s73, 4
  s_add_u32 s73, s73, s74
  s_mul_i32 s73, s73, 2752
  s_add_u32 s73, s73, s70
  s_add_u32 m0, s71, 0
  s_add_u32 s74, s73, 0
  buffer_load_dwordx4 v10, s[28:31], s74 offen lds
  s_add_u32 m0, s71, 1024
  s_add_u32 s74, s73, 22016
  buffer_load_dwordx4 v10, s[28:31], s74 offen lds
  s_add_u32 m0, s71, 2048
  s_add_u32 s74, s73, 88064
  buffer_load_dwordx4 v10, s[28:31], s74 offen lds
  s_add_u32 m0, s71, 3072
  s_add_u32 s74, s73, 110080
  buffer_load_dwordx4 v10, s[28:31], s74 offen lds
  s_lshl_b32 s68, s58, 9
  s_add_u32 s68, s68, 0
  s_waitcnt vmcnt(37)
  ds_read_b64_tr_b16 a[16:17], v11 offset:4096
  ds_read_b64_tr_b16 a[18:19], v11 offset:6144
  ds_read_b64_tr_b16 a[20:21], v11 offset:4104
  ds_read_b64_tr_b16 a[22:23], v11 offset:6152
  ds_read_b64_tr_b16 a[24:25], v12 offset:4096
  ds_read_b64_tr_b16 a[26:27], v12 offset:6144
  ds_read_b64_tr_b16 a[28:29], v12 offset:4104
  ds_read_b64_tr_b16 a[30:31], v12 offset:6152
  v_accvgpr_write_b32 a176, 0
  v_accvgpr_write_b32 a177, 0
  v_accvgpr_write_b32 a178, 0
  v_accvgpr_write_b32 a179, 0
  v_accvgpr_write_b32 a180, 0
  v_accvgpr_write_b32 a181, 0
  v_accvgpr_write_b32 a182, 0
  v_accvgpr_write_b32 a183, 0
  v_accvgpr_write_b32 a184, 0
  v_accvgpr_write_b32 a185, 0
  v_accvgpr_write_b32 a186, 0
  v_accvgpr_write_b32 a187, 0
  v_accvgpr_write_b32 a188, 0
  v_accvgpr_write_b32 a189, 0
  v_accvgpr_write_b32 a190, 0
  v_accvgpr_write_b32 a191, 0
  s_waitcnt vmcnt(33)
  ds_read_b64_tr_b16 a[32:33], v11 offset:8192
  ds_read_b64_tr_b16 a[34:35], v11 offset:10240
  ds_read_b64_tr_b16 a[36:37], v11 offset:8200
  ds_read_b64_tr_b16 a[38:39], v11 offset:10248
  ds_read_b64_tr_b16 a[40:41], v12 offset:8192
  ds_read_b64_tr_b16 a[42:43], v12 offset:10240
  ds_read_b64_tr_b16 a[44:45], v12 offset:8200
  ds_read_b64_tr_b16 a[46:47], v12 offset:10248
  v_accvgpr_write_b32 a192, 0
  v_accvgpr_write_b32 a193, 0
  v_accvgpr_write_b32 a194, 0
  v_accvgpr_write_b32 a195, 0
  v_accvgpr_write_b32 a196, 0
  v_accvgpr_write_b32 a197, 0
  v_accvgpr_write_b32 a198, 0
  v_accvgpr_write_b32 a199, 0
  v_accvgpr_write_b32 a200, 0
  v_accvgpr_write_b32 a201, 0
  v_accvgpr_write_b32 a202, 0
  v_accvgpr_write_b32 a203, 0
  v_accvgpr_write_b32 a204, 0
  v_accvgpr_write_b32 a205, 0
  v_accvgpr_write_b32 a206, 0
  v_accvgpr_write_b32 a207, 0
  s_waitcnt vmcnt(28)
  ds_read_b64_tr_b16 a[48:49], v11 offset:12288
  ds_read_b64_tr_b16 a[50:51], v11 offset:14336
  ds_read_b64_tr_b16 a[52:53], v11 offset:12296
  ds_read_b64_tr_b16 a[54:55], v11 offset:14344
  ds_read_b64_tr_b16 a[56:57], v12 offset:12288
  ds_read_b64_tr_b16 a[58:59], v12 offset:14336
  ds_read_b64_tr_b16 a[60:61], v12 offset:12296
  ds_read_b64_tr_b16 a[62:63], v12 offset:14344
  v_accvgpr_write_b32 a208, 0
  v_accvgpr_write_b32 a209, 0
  v_accvgpr_write_b32 a210, 0
  v_accvgpr_write_b32 a211, 0
  v_accvgpr_write_b32 a212, 0
  v_accvgpr_write_b32 a213, 0
  v_accvgpr_write_b32 a214, 0
  v_accvgpr_write_b32 a215, 0
  v_accvgpr_write_b32 a216, 0
  v_accvgpr_write_b32 a217, 0
  v_accvgpr_write_b32 a218, 0
  v_accvgpr_write_b32 a219, 0
  v_accvgpr_write_b32 a220, 0
  v_accvgpr_write_b32 a221, 0
  v_accvgpr_write_b32 a222, 0
  v_accvgpr_write_b32 a223, 0
  s_waitcnt vmcnt(24)
  ds_read_b64_tr_b16 a[64:65], v11 offset:16384
  ds_read_b64_tr_b16 a[66:67], v11 offset:18432
  ds_read_b64_tr_b16 a[68:69], v11 offset:16392
  ds_read_b64_tr_b16 a[70:71], v11 offset:18440
  ds_read_b64_tr_b16 a[72:73], v12 offset:16384
  ds_read_b64_tr_b16 a[74:75], v12 offset:18432
  ds_read_b64_tr_b16 a[76:77], v12 offset:16392
  ds_read_b64_tr_b16 a[78:79], v12 offset:18440
  v_accvgpr_write_b32 a224, 0
  v_accvgpr_write_b32 a225, 0
  v_accvgpr_write_b32 a226, 0
  v_accvgpr_write_b32 a227, 0
  v_accvgpr_write_b32 a228, 0
  v_accvgpr_write_b32 a229, 0
  v_accvgpr_write_b32 a230, 0
  v_accvgpr_write_b32 a231, 0
  v_accvgpr_write_b32 a232, 0
  v_accvgpr_write_b32 a233, 0
  v_accvgpr_write_b32 a234, 0
  v_accvgpr_write_b32 a235, 0
  v_accvgpr_write_b32 a236, 0
  v_accvgpr_write_b32 a237, 0
  v_accvgpr_write_b32 a238, 0
  v_accvgpr_write_b32 a239, 0
  s_waitcnt vmcnt(20)
  ds_read_b64_tr_b16 a[80:81], v11 offset:20480
  ds_read_b64_tr_b16 a[82:83], v11 offset:22528
  ds_read_b64_tr_b16 a[84:85], v11 offset:20488
  ds_read_b64_tr_b16 a[86:87], v11 offset:22536
  ds_read_b64_tr_b16 a[88:89], v12 offset:20480
  ds_read_b64_tr_b16 a[90:91], v12 offset:22528
  ds_read_b64_tr_b16 a[92:93], v12 offset:20488
  ds_read_b64_tr_b16 a[94:95], v12 offset:22536
  s_waitcnt vmcnt(16)
  ds_read_b64_tr_b16 a[96:97], v11 offset:24576
  ds_read_b64_tr_b16 a[98:99], v11 offset:26624
  ds_read_b64_tr_b16 a[100:101], v11 offset:24584
  ds_read_b64_tr_b16 a[102:103], v11 offset:26632
  ds_read_b64_tr_b16 a[104:105], v12 offset:24576
  ds_read_b64_tr_b16 a[106:107], v12 offset:26624
  ds_read_b64_tr_b16 a[108:109], v12 offset:24584
  ds_read_b64_tr_b16 a[110:111], v12 offset:26632
  s_waitcnt vmcnt(12)
  ds_read_b64_tr_b16 a[112:113], v11 offset:28672
  ds_read_b64_tr_b16 a[114:115], v11 offset:30720
  ds_read_b64_tr_b16 a[116:117], v11 offset:28680
  ds_read_b64_tr_b16 a[118:119], v11 offset:30728
  ds_read_b64_tr_b16 a[120:121], v12 offset:28672
  ds_read_b64_tr_b16 a[122:123], v12 offset:30720
  ds_read_b64_tr_b16 a[124:125], v12 offset:28680
  ds_read_b64_tr_b16 a[126:127], v12 offset:30728
  s_waitcnt vmcnt(8)
  ds_read_b64_tr_b16 a[128:129], v11 offset:32768
  ds_read_b64_tr_b16 a[130:131], v11 offset:34816
  ds_read_b64_tr_b16 a[132:133], v11 offset:32776
  ds_read_b64_tr_b16 a[134:135], v11 offset:34824
  ds_read_b64_tr_b16 a[136:137], v12 offset:32768
  ds_read_b64_tr_b16 a[138:139], v12 offset:34816
  ds_read_b64_tr_b16 a[140:141], v12 offset:32776
  ds_read_b64_tr_b16 a[142:143], v12 offset:34824
  s_waitcnt vmcnt(4)
  ds_read_b64_tr_b16 a[144:145], v11 offset:36864
  ds_read_b64_tr_b16 a[146:147], v11 offset:38912
  ds_read_b64_tr_b16 a[148:149], v11 offset:36872
  ds_read_b64_tr_b16 a[150:151], v11 offset:38920
  ds_read_b64_tr_b16 a[152:153], v12 offset:36864
  ds_read_b64_tr_b16 a[154:155], v12 offset:38912
  ds_read_b64_tr_b16 a[156:157], v12 offset:36872
  ds_read_b64_tr_b16 a[158:159], v12 offset:38920
  buffer_load_dword v16, v14, s[48:51], s68 offen sc1
  buffer_load_dword v17, v15, s[48:51], s68 offen sc1
  s_waitcnt vmcnt(2)
  ds_read_b64_tr_b16 a[160:161], v11 offset:0
  ds_read_b64_tr_b16 a[162:163], v11 offset:2048
  ds_read_b64_tr_b16 a[164:165], v11 offset:8
  ds_read_b64_tr_b16 a[166:167], v11 offset:2056
  ds_read_b64_tr_b16 a[168:169], v12 offset:0
  ds_read_b64_tr_b16 a[170:171], v12 offset:2048
  ds_read_b64_tr_b16 a[172:173], v12 offset:8
  ds_read_b64_tr_b16 a[174:175], v12 offset:2056
  s_waitcnt vmcnt(0)
  s_mov_b32 s62, 200000
PL_3:
  v_cmp_ne_u32 s[64:65], s57, v16
  v_cmp_ne_u32 s[66:67], s57, v17
  s_or_b64 s[64:65], s[64:65], s[66:67]
  s_cmp_eq_u64 s[64:65], 0
  s_cbranch_scc1 PD_4
  s_sub_u32 s62, s62, 1
  s_cbranch_scc1 PD_4
  s_sleep 6
  buffer_load_dword v16, v14, s[48:51], s68 offen sc1
  buffer_load_dword v17, v15, s[48:51], s68 offen sc1
  s_waitcnt vmcnt(0)
  s_branch PL_3
PD_4:
  s_mul_i32 s72, s58, 176
  s_add_u32 s73, s69, 0
  s_cmp_ge_u32 s73, 44
  s_cselect_b32 s75, 44, 0
  s_sub_u32 s73, s73, s75
  s_add_u32 s73, s73, s72
  s_lshl_b32 s73, s73, 10
  s_mov_b32 s74, s73
  buffer_load_dwordx4 v[64:67], v13, s[36:39], s74 offen sc1
  s_add_u32 s74, s73, 45056
  buffer_load_dwordx4 v[68:71], v13, s[36:39], s74 offen sc1
  s_add_u32 s74, s73, 90112
  buffer_load_dwordx4 v[72:75], v13, s[36:39], s74 offen sc1
  s_add_u32 s74, s73, 135168
  buffer_load_dwordx4 v[76:79], v13, s[36:39], s74 offen sc1
  s_add_u32 s73, s69, 1
  s_cmp_ge_u32 s73, 44
  s_cselect_b32 s75, 44, 0
  s_sub_u32 s73, s73, s75
  s_add_u32 s73, s73, s72
  s_lshl_b32 s73, s73, 10
  s_mov_b32 s74, s73
  buffer_load_dwordx4 v[80:83], v13, s[36:39], s74 offen sc1
  s_add_u32 s74, s73, 45056
  buffer_load_dwordx4 v[84:87], v13, s[36:39], s74 offen sc1
  s_add_u32 s74, s73, 90112
  buffer_load_dwordx4 v[88:91], v13, s[36:39], s74 offen sc1
  s_add_u32 s74, s73, 135168
  buffer_load_dwordx4 v[92:95], v13, s[36:39], s74 offen sc1
  s_add_u32 s73, s69, 2
  s_cmp_ge_u32 s73, 44
  s_cselect_b32 s75, 44, 0
  s_sub_u32 s73, s73, s75
  s_add_u32 s73, s73, s72
  s_lshl_b32 s73, s73, 10
  s_mov_b32 s74, s73
  buffer_load_dwordx4 v[96:99], v13, s[36:39], s74 offen sc1
  s_add_u32 s74, s73, 45056
  buffer_load_dwordx4 v[100:103], v13, s[36:39], s74 offen sc1
  s_add_u32 s74, s73, 90112
  buffer_load_dwordx4 v[104:107], v13, s[36:39], s74 offen sc1
  s_add_u32 s74, s73, 135168
  buffer_load_dwordx4 v[108:111], v13, s[36:39], s74 offen sc1
  s_add_u32 s73, s69, 3
  s_cmp_ge_u32 s73, 44
  s_cselect_b32 s75, 44, 0
  s_sub_u32 s73, s73, s75
  s_add_u32 s73, s73, s72
  s_lshl_b32 s73, s73, 10
  s_mov_b32 s74, s73
  buffer_load_dwordx4 v[112:115], v13, s[36:39], s74 offen sc1
  s_add_u32 s74, s73, 45056
  buffer_load_dwordx4 v[116:119], v13, s[36:39], s74 offen sc1
  s_add_u32 s74, s73, 90112
  buffer_load_dwordx4 v[120:123], v13, s[36:39], s74 offen sc1
  s_add_u32 s74, s73, 135168
  buffer_load_dwordx4 v[124:127], v13, s[36:39], s74 offen sc1
  v_and_b32 v18, 3, v0
  v_lshlrev_b32 v18, 2, v18
  s_lshl_b32 s67, s60, 7
  s_add_u32 s67, s67, 8192
  s_waitcnt lgkmcnt(0)
  s_barrier
  s_waitcnt vmcnt(12)
  v_mfma_f32_16x16x32_bf16 a[176:179], v[64:67], a[0:3], a[176:179]
  v_mfma_f32_16x16x32_bf16 a[180:183], v[64:67], a[4:7], a[180:183]
  v_mfma_f32_16x16x32_bf16 a[184:187], v[64:67], a[8:11], a[184:187]
  v_mfma_f32_16x16x32_bf16 a[188:191], v[64:67], a[12:15], a[188:191]
  s_add_u32 s73, s69, 4
  s_cmp_ge_u32 s73, 44
  s_cselect_b32 s75, 44, 0
  s_sub_u32 s73, s73, s75
  s_add_u32 s73, s73, s72
  s_lshl_b32 s73, s73, 10
  s_mov_b32 s74, s73
  buffer_load_dwordx4 v[128:131], v13, s[36:39], s74 offen sc1
  v_mfma_f32_16x16x32_bf16 a[192:195], v[68:71], a[0:3], a[192:195]
  v_mfma_f32_16x16x32_bf16 a[196:199], v[68:71], a[4:7], a[196:199]
  v_mfma_f32_16x16x32_bf16 a[200:203], v[68:71], a[8:11], a[200:203]
  v_mfma_f32_16x16x32_bf16 a[204:207], v[68:71], a[12:15], a[204:207]
  s_add_u32 s74, s73, 45056
  buffer_load_dwordx4 v[132:135], v13, s[36:39], s74 offen sc1
  v_mfma_f32_16x16x32_bf16 a[208:211], v[72:75], a[0:3], a[208:211]
  v_mfma_f32_16x16x32_bf16 a[212:215], v[72:75], a[4:7], a[212:215]
  v_mfma_f32_16x16x32_bf16 a[216:219], v[72:75], a[8:11], a[216:219]
  v_mfma_f32_16x16x32_bf16 a[220:223], v[72:75], a[12:15], a[220:223]
  s_add_u32 s74, s73, 90112
  buffer_load_dwordx4 v[136:139], v13, s[36:39], s74 offen sc1
  v_mfma_f32_16x16x32_bf16 a[224:227], v[76:79], a[0:3], a[224:227]
  v_mfma_f32_16x16x32_bf16 a[228:231], v[76:79], a[4:7], a[228:231]
  v_mfma_f32_16x16x32_bf16 a[232:235], v[76:79], a[8:11], a[232:235]
  v_mfma_f32_16x16x32_bf16 a[236:239], v[76:79], a[12:15], a[236:239]
  s_add_u32 s74, s73, 135168
  buffer_load_dwordx4 v[140:143], v13, s[36:39], s74 offen sc1
  s_waitcnt vmcnt(12)
  v_mfma_f32_16x16x32_bf16 a[176:179], v[80:83], a[16:19], a[176:179]
  v_mfma_f32_16x16x32_bf16 a[180:183], v[80:83], a[20:23], a[180:183]
  v_mfma_f32_16x16x32_bf16 a[184:187], v[80:83], a[24:27], a[184:187]
  v_mfma_f32_16x16x32_bf16 a[188:191], v[80:83], a[28:31], a[188:191]
  s_add_u32 s73, s69, 5
  s_cmp_ge_u32 s73, 44
  s_cselect_b32 s75, 44, 0
  s_sub_u32 s73, s73, s75
  s_add_u32 s73, s73, s72
  s_lshl_b32 s73, s73, 10
  s_mov_b32 s74, s73
  buffer_load_dwordx4 v[144:147], v13, s[36:39], s74 offen sc1
  v_mfma_f32_16x16x32_bf16 a[192:195], v[84:87], a[16:19], a[192:195]
  v_mfma_f32_16x16x32_bf16 a[196:199], v[84:87], a[20:23], a[196:199]
  v_mfma_f32_16x16x32_bf16 a[200:203], v[84:87], a[24:27], a[200:203]
  v_mfma_f32_16x16x32_bf16 a[204:207], v[84:87], a[28:31], a[204:207]
  s_add_u32 s74, s73, 45056
  buffer_load_dwordx4 v[148:151], v13, s[36:39], s74 offen sc1
  v_mfma_f32_16x16x32_bf16 a[208:211], v[88:91], a[16:19], a[208:211]
  v_mfma_f32_16x16x32_bf16 a[212:215], v[88:91], a[20:23], a[212:215]
  v_mfma_f32_16x16x32_bf16 a[216:219], v[88:91], a[24:27], a[216:219]
  v_mfma_f32_16x16x32_bf16 a[220:223], v[88:91], a[28:31], a[220:223]
  s_add_u32 s74, s73, 90112
  buffer_load_dwordx4 v[152:155], v13, s[36:39], s74 offen sc1
  v_mfma_f32_16x16x32_bf16 a[224:227], v[92:95], a[16:19], a[224:227]
  v_mfma_f32_16x16x32_bf16 a[228:231], v[92:95], a[20:23], a[228:231]
  v_mfma_f32_16x16x32_bf16 a[232:235], v[92:95], a[24:27], a[232:235]
  v_mfma_f32_16x16x32_bf16 a[236:239], v[92:95], a[28:31], a[236:239]
  s_add_u32 s74, s73, 135168
  buffer_load_dwordx4 v[156:159], v13, s[36:39], s74 offen sc1
  s_waitcnt vmcnt(12)
  v_mfma_f32_16x16x32_bf16 a[176:179], v[96:99], a[32:35], a[176:179]
  v_mfma_f32_16x16x32_bf16 a[180:183], v[96:99], a[36:39], a[180:183]
  v_mfma_f32_16x16x32_bf16 a[184:187], v[96:99], a[40:43], a[184:187]
  v_mfma_f32_16x16x32_bf16 a[188:191], v[96:99], a[44:47], a[188:191]
  s_add_u32 s73, s69, 6
  s_cmp_ge_u32 s73, 44
  s_cselect_b32 s75, 44, 0
  s_sub_u32 s73, s73, s75
  s_add_u32 s73, s73, s72
  s_lshl_b32 s73, s73, 10
  s_mov_b32 s74, s73
  buffer_load_dwordx4 v[160:163], v13, s[36:39], s74 offen sc1
  v_mfma_f32_16x16x32_bf16 a[192:195], v[100:103], a[32:35], a[192:195]
  v_mfma_f32_16x16x32_bf16 a[196:199], v[100:103], a[36:39], a[196:199]
  v_mfma_f32_16x16x32_bf16 a[200:203], v[100:103], a[40:43], a[200:203]
  v_mfma_f32_16x16x32_bf16 a[204:207], v[100:103], a[44:47], a[204:207]
  s_add_u32 s74, s73, 45056
  buffer_load_dwordx4 v[164:167], v13, s[36:39], s74 offen sc1
  v_mfma_f32_16x16x32_bf16 a[208:211], v[104:107], a[32:35], a[208:211]
  v_mfma_f32_16x16x32_bf16 a[212:215], v[104:107], a[36:39], a[212:215]
  v_mfma_f32_16x16x32_bf16 a[216:219], v[104:107], a[40:43], a[216:219]
  v_mfma_f32_16x16x32_bf16 a[220:223], v[104:107], a[44:47], a[220:223]
  s_add_u32 s74, s73, 90112
  buffer_load_dwordx4 v[168:171], v13, s[36:39], s74 offen sc1
  v_mfma_f32_16x16x32_bf16 a[224:227], v[108:111], a[32:35], a[224:227]
  v_mfma_f32_16x16x32_bf16 a[228:231], v[108:111], a[36:39], a[228:231]
  v_mfma_f32_16x16x32_bf16 a[232:235], v[108:111], a[40:43], a[232:235]
  v_mfma_f32_16x16x32_bf16 a[236:239], v[108:111], a[44:47], a[236:239]
  s_add_u32 s74, s73, 135168
  buffer_load_dwordx4 v[172:175], v13, s[36:39], s74 offen sc1
  s_waitcnt vmcnt(12)
  v_mfma_f32_16x16x32_bf16 a[176:179], v[112:115], a[48:51], a[176:179]
  v_mfma_f32_16x16x32_bf16 a[180:183], v[112:115], a[52:55], a[180:183]
  v_mfma_f32_16x16x32_bf16 a[184:187], v[112:115], a[56:59], a[184:187]
  v_mfma_f32_16x16x32_bf16 a[188:191], v[112:115], a[60:63], a[188:191]
  s_add_u32 s73, s69, 7
  s_cmp_ge_u32 s73, 44
  s_cselect_b32 s75, 44, 0
  s_sub_u32 s73, s73, s75
  s_add_u32 s73, s73, s72
  s_lshl_b32 s73, s73, 10
  s_mov_b32 s74, s73
  buffer_load_dwordx4 v[176:179], v13, s[36:39], s74 offen sc1
  v_mfma_f32_16x16x32_bf16 a[192:195], v[116:119], a[48:51], a[192:195]
  v_mfma_f32_16x16x32_bf16 a[196:199], v[116:119], a[52:55], a[196:199]
  v_mfma_f32_16x16x32_bf16 a[200:203], v[116:119], a[56:59], a[200:203]
  v_mfma_f32_16x16x32_bf16 a[204:207], v[116:119], a[60:63], a[204:207]
  s_add_u32 s74, s73, 45056
  buffer_load_dwordx4 v[180:183], v13, s[36:39], s74 offen sc1
  v_mfma_f32_16x16x32_bf16 a[208:211], v[120:123], a[48:51], a[208:211]
  v_mfma_f32_16x16x32_bf16 a[212:215], v[120:123], a[52:55], a[212:215]
  v_mfma_f32_16x16x32_bf16 a[216:219], v[120:123], a[56:59], a[216:219]
  v_mfma_f32_16x16x32_bf16 a[220:223], v[120:123], a[60:63], a[220:223]
  s_add_u32 s74, s73, 90112
  buffer_load_dwordx4 v[184:187], v13, s[36:39], s74 offen sc1
  v_mfma_f32_16x16x32_bf16 a[224:227], v[124:127], a[48:51], a[224:227]
  v_mfma_f32_16x16x32_bf16 a[228:231], v[124:127], a[52:55], a[228:231]
  v_mfma_f32_16x16x32_bf16 a[232:235], v[124:127], a[56:59], a[232:235]
  v_mfma_f32_16x16x32_bf16 a[236:239], v[124:127], a[60:63], a[236:239]
  s_add_u32 s74, s73, 135168
  buffer_load_dwordx4 v[188:191], v13, s[36:39], s74 offen sc1
  s_waitcnt vmcnt(12)
  v_mfma_f32_16x16x32_bf16 a[176:179], v[128:131], a[64:67], a[176:179]
  v_mfma_f32_16x16x32_bf16 a[180:183], v[128:131], a[68:71], a[180:183]
  v_mfma_f32_16x16x32_bf16 a[184:187], v[128:131], a[72:75], a[184:187]
  v_mfma_f32_16x16x32_bf16 a[188:191], v[128:131], a[76:79], a[188:191]
  s_add_u32 s73, s69, 8
  s_cmp_ge_u32 s73, 44
  s_cselect_b32 s75, 44, 0
  s_sub_u32 s73, s73, s75
  s_add_u32 s73, s73, s72
  s_lshl_b32 s73, s73, 10
  s_mov_b32 s74, s73
  buffer_load_dwordx4 v[192:195], v13, s[36:39], s74 offen sc1
  v_mfma_f32_16x16x32_bf16 a[192:195], v[132:135], a[64:67], a[192:195]
  v_mfma_f32_16x16x32_bf16 a[196:199], v[132:135], a[68:71], a[196:199]
  v_mfma_f32_16x16x32_bf16 a[200:203], v[132:135], a[72:75], a[200:203]
  v_mfma_f32_16x16x32_bf16 a[204:207], v[132:135], a[76:79], a[204:207]
  s_add_u32 s74, s73, 45056
  buffer_load_dwordx4 v[196:199], v13, s[36:39], s74 offen sc1
  v_mfma_f32_16x16x32_bf16 a[208:211], v[136:139], a[64:67], a[208:211]
  v_mfma_f32_16x16x32_bf16 a[212:215], v[136:139], a[68:71], a[212:215]
  v_mfma_f32_16x16x32_bf16 a[216:219], v[136:139], a[72:75], a[216:219]
  v_mfma_f32_16x16x32_bf16 a[220:223], v[136:139], a[76:79], a[220:223]
  s_add_u32 s74, s73, 90112
  buffer_load_dwordx4 v[200:203], v13, s[36:39], s74 offen sc1
  v_mfma_f32_16x16x32_bf16 a[224:227], v[140:143], a[64:67], a[224:227]
  v_mfma_f32_16x16x32_bf16 a[228:231], v[140:143], a[68:71], a[228:231]
  v_mfma_f32_16x16x32_bf16 a[232:235], v[140:143], a[72:75], a[232:235]
  v_mfma_f32_16x16x32_bf16 a[236:239], v[140:143], a[76:79], a[236:239]
  s_add_u32 s74, s73, 135168
  buffer_load_dwordx4 v[204:207], v13, s[36:39], s74 offen sc1
  s_waitcnt vmcnt(12)
  v_mfma_f32_16x16x32_bf16 a[176:179], v[144:147], a[80:83], a[176:179]
  v_mfma_f32_16x16x32_bf16 a[180:183], v[144:147], a[84:87], a[180:183]
  v_mfma_f32_16x16x32_bf16 a[184:187], v[144:147], a[88:91], a[184:187]
  v_mfma_f32_16x16x32_bf16 a[188:191], v[144:147], a[92:95], a[188:191]
  s_add_u32 s73, s69, 9
  s_cmp_ge_u32 s73, 44
  s_cselect_b32 s75, 44, 0
  s_sub_u32 s73, s73, s75
  s_add_u32 s73, s73, s72
  s_lshl_b32 s73, s73, 10
  s_mov_b32 s74, s73
  buffer_load_dwordx4 v[208:211], v13, s[36:39], s74 offen sc1
  v_mfma_f32_16x16x32_bf16 a[192:195], v[148:151], a[80:83], a[192:195]
  v_mfma_f32_16x16x32_bf16 a[196:199], v[148:151], a[84:87], a[196:199]
  v_mfma_f32_16x16x32_bf16 a[200:203], v[148:151], a[88:91], a[200:203]
  v_mfma_f32_16x16x32_bf16 a[204:207], v[148:151], a[92:95], a[204:207]
  s_add_u32 s74, s73, 45056
  buffer_load_dwordx4 v[212:215], v13, s[36:39], s74 offen sc1
  v_mfma_f32_16x16x32_bf16 a[208:211], v[152:155], a[80:83], a[208:211]
  v_mfma_f32_16x16x32_bf16 a[212:215], v[152:155], a[84:87], a[212:215]
  v_mfma_f32_16x16x32_bf16 a[216:219], v[152:155], a[88:91], a[216:219]
  v_mfma_f32_16x16x32_bf16 a[220:223], v[152:155], a[92:95], a[220:223]
  s_add_u32 s74, s73, 90112
  buffer_load_dwordx4 v[216:219], v13, s[36:39], s74 offen sc1
  v_mfma_f32_16x16x32_bf16 a[224:227], v[156:159], a[80:83], a[224:227]
  v_mfma_f32_16x16x32_bf16 a[228:231], v[156:159], a[84:87], a[228:231]
  v_mfma_f32_16x16x32_bf16 a[232:235], v[156:159], a[88:91], a[232:235]
  v_mfma_f32_16x16x32_bf16 a[236:239], v[156:159], a[92:95], a[236:239]
  s_add_u32 s74, s73, 135168
  buffer_load_dwordx4 v[220:223], v13, s[36:39], s74 offen sc1
  s_waitcnt vmcnt(12)
  v_mfma_f32_16x16x32_bf16 a[176:179], v[160:163], a[96:99], a[176:179]
  v_mfma_f32_16x16x32_bf16 a[180:183], v[160:163], a[100:103], a[180:183]
  v_mfma_f32_16x16x32_bf16 a[184:187], v[160:163], a[104:107], a[184:187]
  v_mfma_f32_16x16x32_bf16 a[188:191], v[160:163], a[108:111], a[188:191]
  s_add_u32 s73, s69, 10
  s_cmp_ge_u32 s73, 44
  s_cselect_b32 s75, 44, 0
  s_sub_u32 s73, s73, s75
  s_add_u32 s73, s73, s72
  s_lshl_b32 s73, s73, 10
  s_mov_b32 s74, s73
  buffer_load_dwordx4 v[224:227], v13, s[36:39], s74 offen sc1
  v_mfma_f32_16x16x32_bf16 a[192:195], v[164:167], a[96:99], a[192:195]
  v_mfma_f32_16x16x32_bf16 a[196:199], v[164:167], a[100:103], a[196:199]
  v_mfma_f32_16x16x32_bf16 a[200:203], v[164:167], a[104:107], a[200:203]
  v_mfma_f32_16x16x32_bf16 a[204:207], v[164:167], a[108:111], a[204:207]
  s_add_u32 s74, s73, 45056
  buffer_load_dwordx4 v[228:231], v13, s[36:39], s74 offen sc1
  v_mfma_f32_16x16x32_bf16 a[208:211], v[168:171], a[96:99], a[208:211]
  v_mfma_f32_16x16x32_bf16 a[212:215], v[168:171], a[100:103], a[212:215]
  v_mfma_f32_16x16x32_bf16 a[216:219], v[168:171], a[104:107], a[216:219]
  v_mfma_f32_16x16x32_bf16 a[220:223], v[168:171], a[108:111], a[220:223]
  s_add_u32 s74, s73, 90112
  buffer_load_dwordx4 v[232:235], v13, s[36:39], s74 offen sc1
  v_mfma_f32_16x16x32_bf16 a[224:227], v[172:175], a[96:99], a[224:227]
  v_mfma_f32_16x16x32_bf16 a[228:231], v[172:175], a[100:103], a[228:231]
  v_mfma_f32_16x16x32_bf16 a[232:235], v[172:175], a[104:107], a[232:235]
  v_mfma_f32_16x16x32_bf16 a[236:239], v[172:175], a[108:111], a[236:239]
  s_add_u32 s74, s73, 135168
  buffer_load_dwordx4 v[236:239], v13, s[36:39], s74 offen sc1
  s_waitcnt vmcnt(12)
  v_mfma_f32_16x16x32_bf16 a[176:179], v[176:179], a[112:115], a[176:179]
  v_mfma_f32_16x16x32_bf16 a[180:183], v[176:179], a[116:119], a[180:183]
  v_mfma_f32_16x16x32_bf16 a[184:187], v[176:179], a[120:123], a[184:187]
  v_mfma_f32_16x16x32_bf16 a[188:191], v[176:179], a[124:127], a[188:191]
  v_mfma_f32_16x16x32_bf16 a[192:195], v[180:183], a[112:115], a[192:195]
  v_mfma_f32_16x16x32_bf16 a[196:199], v[180:183], a[116:119], a[196:199]
  v_mfma_f32_16x16x32_bf16 a[200:203], v[180:183], a[120:123], a[200:203]
  v_mfma_f32_16x16x32_bf16 a[204:207], v[180:183], a[124:127], a[204:207]
  v_mfma_f32_16x16x32_bf16 a[208:211], v[184:187], a[112:115], a[208:211]
  v_mfma_f32_16x16x32_bf16 a[212:215], v[184:187], a[116:119], a[212:215]
  v_mfma_f32_16x16x32_bf16 a[216:219], v[184:187], a[120:123], a[216:219]
  v_mfma_f32_16x16x32_bf16 a[220:223], v[184:187], a[124:127], a[220:223]
  v_mfma_f32_16x16x32_bf16 a[224:227], v[188:191], a[112:115], a[224:227]
  v_mfma_f32_16x16x32_bf16 a[228:231], v[188:191], a[116:119], a[228:231]
  v_mfma_f32_16x16x32_bf16 a[232:235], v[188:191], a[120:123], a[232:235]
  v_mfma_f32_16x16x32_bf16 a[236:239], v[188:191], a[124:127], a[236:239]
  s_waitcnt vmcnt(8)
  v_mfma_f32_16x16x32_bf16 a[176:179], v[192:195], a[128:131], a[176:179]
  v_mfma_f32_16x16x32_bf16 a[180:183], v[192:195], a[132:135], a[180:183]
  v_mfma_f32_16x16x32_bf16 a[184:187], v[192:195], a[136:139], a[184:187]
  v_mfma_f32_16x16x32_bf16 a[188:191], v[192:195], a[140:143], a[188:191]
  v_mfma_f32_16x16x32_bf16 a[192:195], v[196:199], a[128:131], a[192:195]
  v_mfma_f32_16x16x32_bf16 a[196:199], v[196:199], a[132:135], a[196:199]
  v_mfma_f32_16x16x32_bf16 a[200:203], v[196:199], a[136:139], a[200:203]
  v_mfma_f32_16x16x32_bf16 a[204:207], v[196:199], a[140:143], a[204:207]
  v_mfma_f32_16x16x32_bf16 a[208:211], v[200:203], a[128:131], a[208:211]
  v_mfma_f32_16x16x32_bf16 a[212:215], v[200:203], a[132:135], a[212:215]
  v_mfma_f32_16x16x32_bf16 a[216:219], v[200:203], a[136:139], a[216:219]
  v_mfma_f32_16x16x32_bf16 a[220:223], v[200:203], a[140:143], a[220:223]
  v_mfma_f32_16x16x32_bf16 a[224:227], v[204:207], a[128:131], a[224:227]
  v_mfma_f32_16x16x32_bf16 a[228:231], v[204:207], a[132:135], a[228:231]
  v_mfma_f32_16x16x32_bf16 a[232:235], v[204:207], a[136:139], a[232:235]
  v_mfma_f32_16x16x32_bf16 a[236:239], v[204:207], a[140:143], a[236:239]
  buffer_load_dword v19, v18, s[48:51], s67 offen sc1
  s_waitcnt vmcnt(5)
  v_mfma_f32_16x16x32_bf16 a[176:179], v[208:211], a[144:147], a[176:179]
  v_mfma_f32_16x16x32_bf16 a[180:183], v[208:211], a[148:151], a[180:183]
  v_mfma_f32_16x16x32_bf16 a[184:187], v[208:211], a[152:155], a[184:187]
  v_mfma_f32_16x16x32_bf16 a[188:191], v[208:211], a[156:159], a[188:191]
  v_mfma_f32_16x16x32_bf16 a[192:195], v[212:215], a[144:147], a[192:195]
  v_mfma_f32_16x16x32_bf16 a[196:199], v[212:215], a[148:151], a[196:199]
  v_mfma_f32_16x16x32_bf16 a[200:203], v[212:215], a[152:155], a[200:203]
  v_mfma_f32_16x16x32_bf16 a[204:207], v[212:215], a[156:159], a[204:207]
  v_mfma_f32_16x16x32_bf16 a[208:211], v[216:219], a[144:147], a[208:211]
  v_mfma_f32_16x16x32_bf16 a[212:215], v[216:219], a[148:151], a[212:215]
  v_mfma_f32_16x16x32_bf16 a[216:219], v[216:219], a[152:155], a[216:219]
  v_mfma_f32_16x16x32_bf16 a[220:223], v[216:219], a[156:159], a[220:223]
  v_mfma_f32_16x16x32_bf16 a[224:227], v[220:223], a[144:147], a[224:227]
  v_mfma_f32_16x16x32_bf16 a[228:231], v[220:223], a[148:151], a[228:231]
  v_mfma_f32_16x16x32_bf16 a[232:235], v[220:223], a[152:155], a[232:235]
  v_mfma_f32_16x16x32_bf16 a[236:239], v[220:223], a[156:159], a[236:239]
  s_waitcnt vmcnt(1)
  v_mfma_f32_16x16x32_bf16 a[176:179], v[224:227], a[160:163], a[176:179]
  v_mfma_f32_16x16x32_bf16 a[180:183], v[224:227], a[164:167], a[180:183]
  v_mfma_f32_16x16x32_bf16 a[184:187], v[224:227], a[168:171], a[184:187]
  v_mfma_f32_16x16x32_bf16 a[188:191], v[224:227], a[172:175], a[188:191]
  v_mfma_f32_16x16x32_bf16 a[192:195], v[228:231], a[160:163], a[192:195]
  v_mfma_f32_16x16x32_bf16 a[196:199], v[228:231], a[164:167], a[196:199]
  v_mfma_f32_16x16x32_bf16 a[200:203], v[228:231], a[168:171], a[200:203]
  v_mfma_f32_16x16x32_bf16 a[204:207], v[228:231], a[172:175], a[204:207]
  v_mfma_f32_16x16x32_bf16 a[208:211], v[232:235], a[160:163], a[208:211]
  v_mfma_f32_16x16x32_bf16 a[212:215], v[232:235], a[164:167], a[212:215]
  v_mfma_f32_16x16x32_bf16 a[216:219], v[232:235], a[168:171], a[216:219]
  v_mfma_f32_16x16x32_bf16 a[220:223], v[232:235], a[172:175], a[220:223]
  v_mfma_f32_16x16x32_bf16 a[224:227], v[236:239], a[160:163], a[224:227]
  v_mfma_f32_16x16x32_bf16 a[228:231], v[236:239], a[164:167], a[228:231]
  v_mfma_f32_16x16x32_bf16 a[232:235], v[236:239], a[168:171], a[232:235]
  v_mfma_f32_16x16x32_bf16 a[236:239], v[236:239], a[172:175], a[236:239]
  s_nop 7
  v_lshlrev_b32 v14, 4, v0
  s_cmp_eq_u32 s56, 0
  s_cbranch_scc0 TR_5
  ds_write_b128 v14, a[184:187] offset:20480
  ds_write_b128 v14, a[188:191] offset:21504
  ds_write_b128 v14, a[200:203] offset:22528
  ds_write_b128 v14, a[204:207] offset:23552
  ds_write_b128 v14, a[208:211] offset:28672
  ds_write_b128 v14, a[212:215] offset:29696
  ds_write_b128 v14, a[224:227] offset:30720
  ds_write_b128 v14, a[228:231] offset:31744
  ds_write_b128 v14, a[216:219] offset:36864
  ds_write_b128 v14, a[220:223] offset:37888
  ds_write_b128 v14, a[232:235] offset:38912
  ds_write_b128 v14, a[236:239] offset:39936
  v_accvgpr_read_b32 v20, a176
  v_accvgpr_read_b32 v21, a177
  v_accvgpr_read_b32 v22, a178
  v_accvgpr_read_b32 v23, a179
  v_accvgpr_read_b32 v24, a180
  v_accvgpr_read_b32 v25, a181
  v_accvgpr_read_b32 v26, a182
  v_accvgpr_read_b32 v27, a183
  v_accvgpr_read_b32 v28, a192
  v_accvgpr_read_b32 v29, a193
  v_accvgpr_read_b32 v30, a194
  v_accvgpr_read_b32 v31, a195
  v_accvgpr_read_b32 v32, a196
  v_accvgpr_read_b32 v33, a197
  v_accvgpr_read_b32 v34, a198
  v_accvgpr_read_b32 v35, a199
TR_5:
  s_cmp_eq_u32 s56, 1
  s_cbranch_scc0 TR_6
  ds_write_b128 v14, a[176:179] offset:0
  ds_write_b128 v14, a[180:183] offset:1024
  ds_write_b128 v14, a[192:195] offset:2048
  ds_write_b128 v14, a[196:199] offset:3072
  ds_write_b128 v14, a[208:211] offset:32768
  ds_write_b128 v14, a[212:215] offset:33792
  ds_write_b128 v14, a[224:227] offset:34816
  ds_write_b128 v14, a[228:231] offset:35840
  ds_write_b128 v14, a[216:219] offset:40960
  ds_write_b128 v14, a[220:223] offset:41984
  ds_write_b128 v14, a[232:235] offset:43008
  ds_write_b128 v14, a[236:239] offset:44032
  v_accvgpr_read_b32 v20, a184
  v_accvgpr_read_b32 v21, a185
  v_accvgpr_read_b32 v22, a186
  v_accvgpr_read_b32 v23, a187
  v_accvgpr_read_b32 v24, a188
  v_accvgpr_read_b32 v25, a189
  v_accvgpr_read_b32 v26, a190
  v_accvgpr_read_b32 v27, a191
  v_accvgpr_read_b32 v28, a200
  v_accvgpr_read_b32 v29, a201
  v_accvgpr_read_b32 v30, a202
  v_accvgpr_read_b32 v31, a203
  v_accvgpr_read_b32 v32, a204
  v_accvgpr_read_b32 v33, a205
  v_accvgpr_read_b32 v34, a206
  v_accvgpr_read_b32 v35, a207
TR_6:
  s_cmp_eq_u32 s56, 2
  s_cbranch_scc0 TR_7
  ds_write_b128 v14, a[176:179] offset:4096
  ds_write_b128 v14, a[180:183] offset:5120
  ds_write_b128 v14, a[192:195] offset:6144
  ds_write_b128 v14, a[196:199] offset:7168
  ds_write_b128 v14, a[184:187] offset:12288
  ds_write_b128 v14, a[188:191] offset:13312
  ds_write_b128 v14, a[200:203] offset:14336
  ds_write_b128 v14, a[204:207] offset:15360
  ds_write_b128 v14, a[216:219] offset:45056
  ds_write_b128 v14, a[220:223] offset:46080
  ds_write_b128 v14, a[232:235] offset:47104
  ds_write_b128 v14, a[236:239] offset:48128
  v_accvgpr_read_b32 v20, a208
  v_accvgpr_read_b32 v21, a209
  v_accvgpr_read_b32 v22, a210
  v_accvgpr_read_b32 v23, a211
  v_accvgpr_read_b32 v24, a212
  v_accvgpr_read_b32 v25, a213
  v_accvgpr_read_b32 v26, a214
  v_accvgpr_read_b32 v27, a215
  v_accvgpr_read_b32 v28, a224
  v_accvgpr_read_b32 v29, a225
  v_accvgpr_read_b32 v30, a226
  v_accvgpr_read_b32 v31, a227
  v_accvgpr_read_b32 v32, a228
  v_accvgpr_read_b32 v33, a229
  v_accvgpr_read_b32 v34, a230
  v_accvgpr_read_b32 v35, a231
TR_7:
  s_cmp_eq_u32 s56, 3
  s_cbranch_scc0 TR_8
  ds_write_b128 v14, a[176:179] offset:8192
  ds_write_b128 v14, a[180:183] offset:9216
  ds_write_b128 v14, a[192:195] offset:10240
  ds_write_b128 v14, a[196:199] offset:11264
  ds_write_b128 v14, a[184:187] offset:16384
  ds_write_b128 v14, a[188:191] offset:17408
  ds_write_b128 v14, a[200:203] offset:18432
  ds_write_b128 v14, a[204:207] offset:19456
  ds_write_b128 v14, a[208:211] offset:24576
  ds_write_b128 v14, a[212:215] offset:25600
  ds_write_b128 v14, a[224:227] offset:26624
  ds_write_b128 v14, a[228:231] offset:27648
  v_accvgpr_read_b32 v20, a216
  v_accvgpr_read_b32 v21, a217
  v_accvgpr_read_b32 v22, a218
  v_accvgpr_read_b32 v23, a219
  v_accvgpr_read_b32 v24, a220
  v_accvgpr_read_b32 v25, a221
  v_accvgpr_read_b32 v26, a222
  v_accvgpr_read_b32 v27, a223
  v_accvgpr_read_b32 v28, a232
  v_accvgpr_read_b32 v29, a233
  v_accvgpr_read_b32 v30, a234
  v_accvgpr_read_b32 v31, a235
  v_accvgpr_read_b32 v32, a236
  v_accvgpr_read_b32 v33, a237
  v_accvgpr_read_b32 v34, a238
  v_accvgpr_read_b32 v35, a239
TR_8:
  s_waitcnt lgkmcnt(0)
  s_barrier
  s_mul_i32 s73, s56, 12288
  v_add_u32 v15, s73, v14
  ds_read_b128 v[36:39], v15 offset:0
  ds_read_b128 v[40:43], v15 offset:1024
  ds_read_b128 v[44:47], v15 offset:2048
  ds_read_b128 v[48:51], v15 offset:3072
  ds_read_b128 v[52:55], v15 offset:4096
  ds_read_b128 v[56:59], v15 offset:5120
  ds_read_b128 v[60:63], v15 offset:6144
  ds_read_b128 v[64:67], v15 offset:7168
  ds_read_b128 v[68:71], v15 offset:8192
  ds_read_b128 v[72:75], v15 offset:9216
  ds_read_b128 v[76:79], v15 offset:10240
  ds_read_b128 v[80:83], v15 offset:11264
  s_lshr_b32 s62, s56, 1
  s_and_b32 s63, s56, 1
  s_lshl_b32 s64, s59, 1
  s_add_u32 s64, s64, s63
  s_lshl_b32 s65, s58, 1
  s_add_u32 s65, s65, s62
  s_lshl_b32 s70, s64, 5
  s_add_u32 s70, s70, s65
  s_lshl_b32 s70, s70, 10
  s_add_u32 s71, s70, 16384
  s_lshl_b32 s64, s59, 7
  s_lshl_b32 s65, s58, 2
  s_add_u32 s64, s64, s65
  s_add_u32 s72, s64, 4096
  s_waitcnt lgkmcnt(8)
  v_add_f32 v20, v20, v36
  v_add_f32 v21, v21, v37
  v_add_f32 v22, v22, v38
  v_add_f32 v23, v23, v39
  v_add_f32 v24, v24, v40
  v_add_f32 v25, v25, v41
  v_add_f32 v26, v26, v42
  v_add_f32 v27, v27, v43
  v_add_f32 v28, v28, v44
  v_add_f32 v29, v29, v45
  v_add_f32 v30, v30, v46
  v_add_f32 v31, v31, v47
  v_add_f32 v32, v32, v48
  v_add_f32 v33, v33, v49
  v_add_f32 v34, v34, v50
  v_add_f32 v35, v35, v51
  s_waitcnt lgkmcnt(4)
  v_add_f32 v20, v20, v52
  v_add_f32 v21, v21, v53
  v_add_f32 v22, v22, v54
  v_add_f32 v23, v23, v55
  v_add_f32 v24, v24, v56
  v_add_f32 v25, v25, v57
  v_add_f32 v26, v26, v58
  v_add_f32 v27, v27, v59
  v_add_f32 v28, v28, v60
  v_add_f32 v29, v29, v61
  v_add_f32 v30, v30, v62
  v_add_f32 v31, v31, v63
  v_add_f32 v32, v32, v64
  v_add_f32 v33, v33, v65
  v_add_f32 v34, v34, v66
  v_add_f32 v35, v35, v67
  s_waitcnt lgkmcnt(0)
  v_add_f32 v20, v20, v68
  v_add_f32 v21, v21, v69
  v_add_f32 v22, v22, v70
  v_add_f32 v23, v23, v71
  v_add_f32 v24, v24, v72
  v_add_f32 v25, v25, v73
  v_add_f32 v26, v26, v74
  v_add_f32 v27, v27, v75
  v_add_f32 v28, v28, v76
  v_add_f32 v29, v29, v77
  v_add_f32 v30, v30, v78
  v_add_f32 v31, v31, v79
  v_add_f32 v32, v32, v80
  v_add_f32 v33, v33, v81
  v_add_f32 v34, v34, v82
  v_add_f32 v35, v35, v83
  v_cvt_pk_bf16_f32 v88, v20, v21
  v_cvt_pk_bf16_f32 v89, v22, v23
  v_cvt_pk_bf16_f32 v90, v28, v29
  v_cvt_pk_bf16_f32 v91, v30, v31
  buffer_store_dwordx4 v[88:91], v14, s[44:47], s70 offen sc1
  v_cvt_pk_bf16_f32 v92, v24, v25
  v_cvt_pk_bf16_f32 v93, v26, v27
  v_cvt_pk_bf16_f32 v94, v32, v33
  v_cvt_pk_bf16_f32 v95, v34, v35
  buffer_store_dwordx4 v[92:95], v14, s[44:47], s71 offen sc1
  buffer_load_dword v19, v18, s[48:51], s67 offen sc1
  s_waitcnt vmcnt(0)
  s_barrier
  s_cmp_eq_u32 s56, 0
  s_cbranch_scc0 WF_11
  v_mov_b32 v2, s57
  s_mov_b64 exec, 1
  buffer_store_dword v2, off, s[48:51], s72 sc1
  s_mov_b64 exec, -1
WF_11:
  v_and_b32 v12, 7, v0
  v_lshlrev_b32 v12, 2, v12
  v_bfe_u32 v13, v0, 3, 1
  s_cmp_eq_u32 s61, 14
  s_cselect_b32 s63, 0, 128
  v_mul_u32_u24 v13, s63, v13
  v_add_u32 v12, v12, v13
  s_min_u32 s68, s61, 14
  s_mul_i32 s68, s68, 3
  s_lshr_b32 s68, s68, 1
  s_lshl_b32 s68, s68, 7
  s_add_u32 s68, s68, 4096
  s_mov_b32 s62, 200000
PL_9:
  v_cmp_ne_u32 s[64:65], s57, v19
  s_cmp_eq_u64 s[64:65], 0
  s_cbranch_scc1 PD_10
  s_sub_u32 s62, s62, 1
  s_cbranch_scc1 PD_10
  s_sleep 4
  buffer_load_dword v19, v18, s[48:51], s67 offen sc1
  s_waitcnt vmcnt(0)
  s_branch PL_9
PD_10:
  s_cmp_ge_u32 s61, 15
  s_cbranch_scc1 YX_12
  s_and_b32 s74, s60, 3
  s_lshl_b32 s74, s74, 2
  s_and_b32 s75, s61, 7
  s_lshl_b32 s75, s75, 1
  s_add_u32 s74, s74, s75
  v_lshlrev_b32 v10, 4, v0
  s_lshl_b32 s69, s60, 17
  s_lshl_b32 s75, s56, 15
  s_add_u32 s69, s69, s75
  s_add_u32 s75, s74, 0
  s_and_b32 s75, s75, 15
  s_lshl_b32 s75, s75, 10
  s_add_u32 s75, s75, s69
  buffer_load_dwordx4 a[0:3], v10, s[40:43], s75 offen sc1
  s_add_u32 s75, s75, 16384
  buffer_load_dwordx4 a[4:7], v10, s[40:43], s75 offen sc1
  s_add_u32 s75, s74, 1
  s_and_b32 s75, s75, 15
  s_lshl_b32 s75, s75, 10
  s_add_u32 s75, s75, s69
  buffer_load_dwordx4 a[8:11], v10, s[40:43], s75 offen sc1
  s_add_u32 s75, s75, 16384
  buffer_load_dwordx4 a[12:15], v10, s[40:43], s75 offen sc1
  s_add_u32 s75, s74, 2
  s_and_b32 s75, s75, 15
  s_lshl_b32 s75, s75, 10
  s_add_u32 s75, s75, s69
  buffer_load_dwordx4 a[16:19], v10, s[40:43], s75 offen sc1
  s_add_u32 s75, s75, 16384
  buffer_load_dwordx4 a[20:23], v10, s[40:43], s75 offen sc1
  s_add_u32 s75, s74, 3
  s_and_b32 s75, s75, 15
  s_lshl_b32 s75, s75, 10
  s_add_u32 s75, s75, s69
  buffer_load_dwordx4 a[24:27], v10, s[40:43], s75 offen sc1
  s_add_u32 s75, s75, 16384
  buffer_load_dwordx4 a[28:31], v10, s[40:43], s75 offen sc1
  s_add_u32 s75, s74, 4
  s_and_b32 s75, s75, 15
  s_lshl_b32 s75, s75, 10
  s_add_u32 s75, s75, s69
  buffer_load_dwordx4 a[32:35], v10, s[40:43], s75 offen sc1
  s_add_u32 s75, s75, 16384
  buffer_load_dwordx4 a[36:39], v10, s[40:43], s75 offen sc1
  s_add_u32 s75, s74, 5
  s_and_b32 s75, s75, 15
  s_lshl_b32 s75, s75, 10
  s_add_u32 s75, s75, s69
  buffer_load_dwordx4 a[40:43], v10, s[40:43], s75 offen sc1
  s_add_u32 s75, s75, 16384
  buffer_load_dwordx4 a[44:47], v10, s[40:43], s75 offen sc1
  s_add_u32 s75, s74, 6
  s_and_b32 s75, s75, 15
  s_lshl_b32 s75, s75, 10
  s_add_u32 s75, s75, s69
  buffer_load_dwordx4 a[48:51], v10, s[40:43], s75 offen sc1
  s_add_u32 s75, s75, 16384
  buffer_load_dwordx4 a[52:55], v10, s[40:43], s75 offen sc1
  s_add_u32 s75, s74, 7
  s_and_b32 s75, s75, 15
  s_lshl_b32 s75, s75, 10
  s_add_u32 s75, s75, s69
  buffer_load_dwordx4 a[56:59], v10, s[40:43], s75 offen sc1
  s_add_u32 s75, s75, 16384
  buffer_load_dwordx4 a[60:63], v10, s[40:43], s75 offen sc1
  s_add_u32 s75, s74, 8
  s_and_b32 s75, s75, 15
  s_lshl_b32 s75, s75, 10
  s_add_u32 s75, s75, s69
  buffer_load_dwordx4 a[64:67], v10, s[40:43], s75 offen sc1
  s_add_u32 s75, s75, 16384
  buffer_load_dwordx4 a[68:71], v10, s[40:43], s75 offen sc1
  s_add_u32 s75, s74, 9
  s_and_b32 s75, s75, 15
  s_lshl_b32 s75, s75, 10
  s_add_u32 s75, s75, s69
  buffer_load_dwordx4 a[72:75], v10, s[40:43], s75 offen sc1
  s_add_u32 s75, s75, 16384
  buffer_load_dwordx4 a[76:79], v10, s[40:43], s75 offen sc1
  s_add_u32 s75, s74, 10
  s_and_b32 s75, s75, 15
  s_lshl_b32 s75, s75, 10
  s_add_u32 s75, s75, s69
  buffer_load_dwordx4 a[80:83], v10, s[40:43], s75 offen sc1
  s_add_u32 s75, s75, 16384
  buffer_load_dwordx4 a[84:87], v10, s[40:43], s75 offen sc1
  s_add_u32 s75, s74, 11
  s_and_b32 s75, s75, 15
  s_lshl_b32 s75, s75, 10
  s_add_u32 s75, s75, s69
  buffer_load_dwordx4 a[88:91], v10, s[40:43], s75 offen sc1
  s_add_u32 s75, s75, 16384
  buffer_load_dwordx4 a[92:95], v10, s[40:43], s75 offen sc1
YX_12:
  buffer_load_dword v14, v12, s[48:51], s68 offen sc1
  s_cmp_ge_u32 s61, 15
  s_cbranch_scc1 YX_13
  s_and_b32 s74, s60, 3
  s_lshl_b32 s74, s74, 2
  s_and_b32 s75, s61, 7
  s_lshl_b32 s75, s75, 1
  s_add_u32 s74, s74, s75
  v_lshlrev_b32 v10, 4, v0
  s_lshl_b32 s69, s60, 17
  s_lshl_b32 s75, s56, 15
  s_add_u32 s69, s69, s75
  s_add_u32 s75, s74, 12
  s_and_b32 s75, s75, 15
  s_lshl_b32 s75, s75, 10
  s_add_u32 s75, s75, s69
  buffer_load_dwordx4 a[96:99], v10, s[40:43], s75 offen sc1
  s_add_u32 s75, s75, 16384
  buffer_load_dwordx4 a[100:103], v10, s[40:43], s75 offen sc1
  s_add_u32 s75, s74, 13
  s_and_b32 s75, s75, 15
  s_lshl_b32 s75, s75, 10
  s_add_u32 s75, s75, s69
  buffer_load_dwordx4 a[104:107], v10, s[40:43], s75 offen sc1
  s_add_u32 s75, s75, 16384
  buffer_load_dwordx4 a[108:111], v10, s[40:43], s75 offen sc1
  s_add_u32 s75, s74, 14
  s_and_b32 s75, s75, 15
  s_lshl_b32 s75, s75, 10
  s_add_u32 s75, s75, s69
  buffer_load_dwordx4 a[112:115], v10, s[40:43], s75 offen sc1
  s_add_u32 s75, s75, 16384
  buffer_load_dwordx4 a[116:119], v10, s[40:43], s75 offen sc1
  s_add_u32 s75, s74, 15
  s_and_b32 s75, s75, 15
  s_lshl_b32 s75, s75, 10
  s_add_u32 s75, s75, s69
  buffer_load_dwordx4 a[120:123], v10, s[40:43], s75 offen sc1
  s_add_u32 s75, s75, 16384
  buffer_load_dwordx4 a[124:127], v10, s[40:43], s75 offen sc1
YX_13:
K_y:
  s_cmp_ge_u32 s61, 15
  s_cbranch_scc1 K_fin
  s_and_b32 s74, s60, 3
  s_lshl_b32 s74, s74, 2
  s_and_b32 s75, s61, 7
  s_lshl_b32 s75, s75, 1
  s_add_u32 s74, s74, s75
  v_lshlrev_b32 v10, 4, v0
  v_add_u32 v11, 0x10000, v10
  v_mov_b32 v16, 0
  v_mov_b32 v17, 0
  v_mov_b32 v18, 0
  v_mov_b32 v19, 0
  v_mov_b32 v20, 0
  v_mov_b32 v21, 0
  v_mov_b32 v22, 0
  v_mov_b32 v23, 0
  v_mov_b32 v24, 0
  v_mov_b32 v25, 0
  v_mov_b32 v26, 0
  v_mov_b32 v27, 0
  v_mov_b32 v28, 0
  v_mov_b32 v29, 0
  v_mov_b32 v30, 0
  v_mov_b32 v31, 0
  v_mov_b32 v32, 0
  v_mov_b32 v33, 0
  v_mov_b32 v34, 0
  v_mov_b32 v35, 0
  v_mov_b32 v36, 0
  v_mov_b32 v37, 0
  v_mov_b32 v38, 0
  v_mov_b32 v39, 0
  v_mov_b32 v40, 0
  v_mov_b32 v41, 0
  v_mov_b32 v42, 0
  v_mov_b32 v43, 0
  v_mov_b32 v44, 0
  v_mov_b32 v45, 0
  v_mov_b32 v46, 0
  v_mov_b32 v47, 0
  v_mov_b32 v48, 0
  v_mov_b32 v49, 0
  v_mov_b32 v50, 0
  v_mov_b32 v51, 0
  v_mov_b32 v52, 0
  v_mov_b32 v53, 0
  v_mov_b32 v54, 0
  v_mov_b32 v55, 0
  v_mov_b32 v56, 0
  v_mov_b32 v57, 0
  v_mov_b32 v58, 0
  v_mov_b32 v59, 0
  v_mov_b32 v60, 0
  v_mov_b32 v61, 0
  v_mov_b32 v62, 0
  v_mov_b32 v63, 0
  s_waitcnt vmcnt(8)
  s_mov_b32 s62, 200000
PL_14:
  v_cmp_ne_u32 s[64:65], s57, v14
  s_cmp_eq_u64 s[64:65], 0
  s_cbranch_scc1 PD_15
  s_sub_u32 s62, s62, 1
  s_cbranch_scc1 PD_15
  s_sleep 6
  buffer_load_dword v14, v12, s[48:51], s68 offen sc1
  s_waitcnt vmcnt(0)
  s_branch PL_14
PD_15:
  s_mul_i32 s69, s61, 98304
  s_and_b32 s71, s56, 1
  s_mul_i32 s71, s71, 49152
  s_add_u32 s69, s69, s71
  s_lshr_b32 s73, s56, 1
  s_add_u32 s73, s73, s74
  s_mul_i32 s72, s56, 3072
  s_add_u32 s70, s73, 0
  s_and_b32 s70, s70, 15
  s_lshl_b32 s70, s70, 10
  s_add_u32 s70, s70, s69
  s_add_u32 m0, s72, 0
  s_add_u32 s71, s70, 0
  buffer_load_dwordx4 v10, s[44:47], s71 offen sc1 lds
  s_add_u32 m0, s72, 1024
  s_add_u32 s71, s70, 16384
  buffer_load_dwordx4 v10, s[44:47], s71 offen sc1 lds
  s_add_u32 m0, s72, 2048
  s_add_u32 s71, s70, 32768
  buffer_load_dwordx4 v10, s[44:47], s71 offen sc1 lds
  s_add_u32 s70, s73, 2
  s_and_b32 s70, s70, 15
  s_lshl_b32 s70, s70, 10
  s_add_u32 s70, s70, s69
  s_add_u32 m0, s72, 12288
  s_add_u32 s71, s70, 0
  buffer_load_dwordx4 v10, s[44:47], s71 offen sc1 lds
  s_add_u32 m0, s72, 13312
  s_add_u32 s71, s70, 16384
  buffer_load_dwordx4 v10, s[44:47], s71 offen sc1 lds
  s_add_u32 m0, s72, 14336
  s_add_u32 s71, s70, 32768
  buffer_load_dwordx4 v10, s[44:47], s71 offen sc1 lds
  s_add_u32 s70, s73, 4
  s_and_b32 s70, s70, 15
  s_lshl_b32 s70, s70, 10
  s_add_u32 s70, s70, s69
  s_add_u32 m0, s72, 24576
  s_add_u32 s71, s70, 0
  buffer_load_dwordx4 v10, s[44:47], s71 offen sc1 lds
  s_add_u32 m0, s72, 25600
  s_add_u32 s71, s70, 16384
  buffer_load_dwordx4 v10, s[44:47], s71 offen sc1 lds
  s_add_u32 m0, s72, 26624
  s_add_u32 s71, s70, 32768
  buffer_load_dwordx4 v10, s[44:47], s71 offen sc1 lds
  s_add_u32 s70, s73, 6
  s_and_b32 s70, s70, 15
  s_lshl_b32 s70, s70, 10
  s_add_u32 s70, s70, s69
  s_add_u32 m0, s72, 36864
  s_add_u32 s71, s70, 0
  buffer_load_dwordx4 v10, s[44:47], s71 offen sc1 lds
  s_add_u32 m0, s72, 37888
  s_add_u32 s71, s70, 16384
  buffer_load_dwordx4 v10, s[44:47], s71 offen sc1 lds
  s_add_u32 m0, s72, 38912
  s_add_u32 s71, s70, 32768
  buffer_load_dwordx4 v10, s[44:47], s71 offen sc1 lds
  s_waitcnt vmcnt(9)
  s_barrier
  ds_read_b128 v[64:67], v10 offset:0
  ds_read_b128 v[68:71], v10 offset:1024
  ds_read_b128 v[72:75], v10 offset:2048
  ds_read_b128 v[76:79], v10 offset:3072
  ds_read_b128 v[80:83], v10 offset:4096
  ds_read_b128 v[84:87], v10 offset:5120
  ds_read_b128 v[88:91], v10 offset:6144
  ds_read_b128 v[92:95], v10 offset:7168
  ds_read_b128 v[96:99], v10 offset:8192
  ds_read_b128 v[100:103], v10 offset:9216
  ds_read_b128 v[104:107], v10 offset:10240
  ds_read_b128 v[108:111], v10 offset:11264
  s_waitcnt vmcnt(6)
  s_waitcnt lgkmcnt(0)
  s_barrier
  v_mfma_f32_16x16x32_bf16 v[16:19], v[64:67], a[0:3], v[16:19]
  v_mfma_f32_16x16x32_bf16 v[20:23], v[64:67], a[4:7], v[20:23]
  ds_read_b128 v[112:115], v10 offset:12288
  v_mfma_f32_16x16x32_bf16 v[24:27], v[68:71], a[0:3], v[24:27]
  v_mfma_f32_16x16x32_bf16 v[28:31], v[68:71], a[4:7], v[28:31]
  ds_read_b128 v[116:119], v10 offset:13312
  v_mfma_f32_16x16x32_bf16 v[32:35], v[72:75], a[0:3], v[32:35]
  v_mfma_f32_16x16x32_bf16 v[36:39], v[72:75], a[4:7], v[36:39]
  ds_read_b128 v[120:123], v10 offset:14336
  v_mfma_f32_16x16x32_bf16 v[40:43], v[76:79], a[0:3], v[40:43]
  v_mfma_f32_16x16x32_bf16 v[44:47], v[76:79], a[4:7], v[44:47]
  ds_read_b128 v[124:127], v10 offset:15360
  s_add_u32 s70, s73, 8
  s_and_b32 s70, s70, 15
  s_lshl_b32 s70, s70, 10
  s_add_u32 s70, s70, s69
  s_add_u32 m0, s72, 49152
  s_add_u32 s71, s70, 0
  buffer_load_dwordx4 v10, s[44:47], s71 offen sc1 lds
  v_mfma_f32_16x16x32_bf16 v[48:51], v[80:83], a[0:3], v[48:51]
  v_mfma_f32_16x16x32_bf16 v[52:55], v[80:83], a[4:7], v[52:55]
  ds_read_b128 v[128:131], v10 offset:16384
  v_mfma_f32_16x16x32_bf16 v[56:59], v[84:87], a[0:3], v[56:59]
  v_mfma_f32_16x16x32_bf16 v[60:63], v[84:87], a[4:7], v[60:63]
  ds_read_b128 v[132:135], v10 offset:17408
  v_mfma_f32_16x16x32_bf16 v[16:19], v[88:91], a[8:11], v[16:19]
  v_mfma_f32_16x16x32_bf16 v[20:23], v[88:91], a[12:15], v[20:23]
  ds_read_b128 v[136:139], v10 offset:18432
  v_mfma_f32_16x16x32_bf16 v[24:27], v[92:95], a[8:11], v[24:27]
  v_mfma_f32_16x16x32_bf16 v[28:31], v[92:95], a[12:15], v[28:31]
  ds_read_b128 v[140:143], v10 offset:19456
  s_add_u32 m0, s72, 50176
  s_add_u32 s71, s70, 16384
  buffer_load_dwordx4 v10, s[44:47], s71 offen sc1 lds
  v_mfma_f32_16x16x32_bf16 v[32:35], v[96:99], a[8:11], v[32:35]
  v_mfma_f32_16x16x32_bf16 v[36:39], v[96:99], a[12:15], v[36:39]
  ds_read_b128 v[144:147], v10 offset:20480
  v_mfma_f32_16x16x32_bf16 v[40:43], v[100:103], a[8:11], v[40:43]
  v_mfma_f32_16x16x32_bf16 v[44:47], v[100:103], a[12:15], v[44:47]
  ds_read_b128 v[148:151], v10 offset:21504
  v_mfma_f32_16x16x32_bf16 v[48:51], v[104:107], a[8:11], v[48:51]
  v_mfma_f32_16x16x32_bf16 v[52:55], v[104:107], a[12:15], v[52:55]
  ds_read_b128 v[152:155], v10 offset:22528
  v_mfma_f32_16x16x32_bf16 v[56:59], v[108:111], a[8:11], v[56:59]
  v_mfma_f32_16x16x32_bf16 v[60:63], v[108:111], a[12:15], v[60:63]
  ds_read_b128 v[156:159], v10 offset:23552
  s_add_u32 m0, s72, 51200
  s_add_u32 s71, s70, 32768
  buffer_load_dwordx4 v10, s[44:47], s71 offen sc1 lds
  s_waitcnt vmcnt(6)
  s_waitcnt lgkmcnt(0)
  s_barrier
  v_mfma_f32_16x16x32_bf16 v[16:19], v[112:115], a[16:19], v[16:19]
  v_mfma_f32_16x16x32_bf16 v[20:23], v[112:115], a[20:23], v[20:23]
  ds_read_b128 v[64:67], v10 offset:24576
  v_mfma_f32_16x16x32_bf16 v[24:27], v[116:119], a[16:19], v[24:27]
  v_mfma_f32_16x16x32_bf16 v[28:31], v[116:119], a[20:23], v[28:31]
  ds_read_b128 v[68:71], v10 offset:25600
  v_mfma_f32_16x16x32_bf16 v[32:35], v[120:123], a[16:19], v[32:35]
  v_mfma_f32_16x16x32_bf16 v[36:39], v[120:123], a[20:23], v[36:39]
  ds_read_b128 v[72:75], v10 offset:26624
  v_mfma_f32_16x16x32_bf16 v[40:43], v[124:127], a[16:19], v[40:43]
  v_mfma_f32_16x16x32_bf16 v[44:47], v[124:127], a[20:23], v[44:47]
  ds_read_b128 v[76:79], v10 offset:27648
  s_add_u32 s70, s73, 10
  s_and_b32 s70, s70, 15
  s_lshl_b32 s70, s70, 10
  s_add_u32 s70, s70, s69
  s_add_u32 m0, s72, 61440
  s_add_u32 s71, s70, 0
  buffer_load_dwordx4 v10, s[44:47], s71 offen sc1 lds
  v_mfma_f32_16x16x32_bf16 v[48:51], v[128:131], a[16:19], v[48:51]
  v_mfma_f32_16x16x32_bf16 v[52:55], v[128:131], a[20:23], v[52:55]
  ds_read_b128 v[80:83], v10 offset:28672
  v_mfma_f32_16x16x32_bf16 v[56:59], v[132:135], a[16:19], v[56:59]
  v_mfma_f32_16x16x32_bf16 v[60:63], v[132:135], a[20:23], v[60:63]
  ds_read_b128 v[84:87], v10 offset:29696
  v_mfma_f32_16x16x32_bf16 v[16:19], v[136:139], a[24:27], v[16:19]
  v_mfma_f32_16x16x32_bf16 v[20:23], v[136:139], a[28:31], v[20:23]
  ds_read_b128 v[88:91], v10 offset:30720
  v_mfma_f32_16x16x32_bf16 v[24:27], v[140:143], a[24:27], v[24:27]
  v_mfma_f32_16x16x32_bf16 v[28:31], v[140:143], a[28:31], v[28:31]
  ds_read_b128 v[92:95], v10 offset:31744
  s_add_u32 m0, s72, 62464
  s_add_u32 s71, s70, 16384
  buffer_load_dwordx4 v10, s[44:47], s71 offen sc1 lds
  v_mfma_f32_16x16x32_bf16 v[32:35], v[144:147], a[24:27], v[32:35]
  v_mfma_f32_16x16x32_bf16 v[36:39], v[144:147], a[28:31], v[36:39]
  ds_read_b128 v[96:99], v10 offset:32768
  v_mfma_f32_16x16x32_bf16 v[40:43], v[148:151], a[24:27], v[40:43]
  v_mfma_f32_16x16x32_bf16 v[44:47], v[148:151], a[28:31], v[44:47]
  ds_read_b128 v[100:103], v10 offset:33792
  v_mfma_f32_16x16x32_bf16 v[48:51], v[152:155], a[24:27], v[48:51]
  v_mfma_f32_16x16x32_bf16 v[52:55], v[152:155], a[28:31], v[52:55]
  ds_read_b128 v[104:107], v10 offset:34816
  v_mfma_f32_16x16x32_bf16 v[56:59], v[156:159], a[24:27], v[56:59]
  v_mfma_f32_16x16x32_bf16 v[60:63], v[156:159], a[28:31], v[60:63]
  ds_read_b128 v[108:111], v10 offset:35840
  s_add_u32 m0, s72, 63488
  s_add_u32 s71, s70, 32768
  buffer_load_dwordx4 v10, s[44:47], s71 offen sc1 lds
  s_waitcnt vmcnt(6)
  s_waitcnt lgkmcnt(0)
  s_barrier
  v_mfma_f32_16x16x32_bf16 v[16:19], v[64:67], a[32:35], v[16:19]
  v_mfma_f32_16x16x32_bf16 v[20:23], v[64:67], a[36:39], v[20:23]
  ds_read_b128 v[112:115], v10 offset:36864
  v_mfma_f32_16x16x32_bf16 v[24:27], v[68:71], a[32:35], v[24:27]
  v_mfma_f32_16x16x32_bf16 v[28:31], v[68:71], a[36:39], v[28:31]
  ds_read_b128 v[116:119], v10 offset:37888
  v_mfma_f32_16x16x32_bf16 v[32:35], v[72:75], a[32:35], v[32:35]
  v_mfma_f32_16x16x32_bf16 v[36:39], v[72:75], a[36:39], v[36:39]
  ds_read_b128 v[120:123], v10 offset:38912
  v_mfma_f32_16x16x32_bf16 v[40:43], v[76:79], a[32:35], v[40:43]
  v_mfma_f32_16x16x32_bf16 v[44:47], v[76:79], a[36:39], v[44:47]
  ds_read_b128 v[124:127], v10 offset:39936
  s_add_u32 s70, s73, 12
  s_and_b32 s70, s70, 15
  s_lshl_b32 s70, s70, 10
  s_add_u32 s70, s70, s69
  s_add_u32 m0, s72, 73728
  s_add_u32 s71, s70, 0
  buffer_load_dwordx4 v10, s[44:47], s71 offen sc1 lds
  v_mfma_f32_16x16x32_bf16 v[48:51], v[80:83], a[32:35], v[48:51]
  v_mfma_f32_16x16x32_bf16 v[52:55], v[80:83], a[36:39], v[52:55]
  ds_read_b128 v[128:131], v10 offset:40960
  v_mfma_f32_16x16x32_bf16 v[56:59], v[84:87], a[32:35], v[56:59]
  v_mfma_f32_16x16x32_bf16 v[60:63], v[84:87], a[36:39], v[60:63]
  ds_read_b128 v[132:135], v10 offset:41984
  v_mfma_f32_16x16x32_bf16 v[16:19], v[88:91], a[40:43], v[16:19]
  v_mfma_f32_16x16x32_bf16 v[20:23], v[88:91], a[44:47], v[20:23]
  ds_read_b128 v[136:139], v10 offset:43008
  v_mfma_f32_16x16x32_bf16 v[24:27], v[92:95], a[40:43], v[24:27]
  v_mfma_f32_16x16x32_bf16 v[28:31], v[92:95], a[44:47], v[28:31]
  ds_read_b128 v[140:143], v10 offset:44032
  s_add_u32 m0, s72, 74752
  s_add_u32 s71, s70, 16384
  buffer_load_dwordx4 v10, s[44:47], s71 offen sc1 lds
  v_mfma_f32_16x16x32_bf16 v[32:35], v[96:99], a[40:43], v[32:35]
  v_mfma_f32_16x16x32_bf16 v[36:39], v[96:99], a[44:47], v[36:39]
  ds_read_b128 v[144:147], v10 offset:45056
  v_mfma_f32_16x16x32_bf16 v[40:43], v[100:103], a[40:43], v[40:43]
  v_mfma_f32_16x16x32_bf16 v[44:47], v[100:103], a[44:47], v[44:47]
  ds_read_b128 v[148:151], v10 offset:46080
  v_mfma_f32_16x16x32_bf16 v[48:51], v[104:107], a[40:43], v[48:51]
  v_mfma_f32_16x16x32_bf16 v[52:55], v[104:107], a[44:47], v[52:55]
  ds_read_b128 v[152:155], v10 offset:47104
  v_mfma_f32_16x16x32_bf16 v[56:59], v[108:111], a[40:43], v[56:59]
  v_mfma_f32_16x16x32_bf16 v[60:63], v[108:111], a[44:47], v[60:63]
  ds_read_b128 v[156:159], v10 offset:48128
  s_add_u32 m0, s72, 75776
  s_add_u32 s71, s70, 32768
  buffer_load_dwordx4 v10, s[44:47], s71 offen sc1 lds
  s_waitcnt vmcnt(6)
  s_waitcnt lgkmcnt(0)
  s_barrier
  v_mfma_f32_16x16x32_bf16 v[16:19], v[112:115], a[48:51], v[16:19]
  v_mfma_f32_16x16x32_bf16 v[20:23], v[112:115], a[52:55], v[20:23]
  ds_read_b128 v[64:67], v10 offset:49152
  v_mfma_f32_16x16x32_bf16 v[24:27], v[116:119], a[48:51], v[24:27]
  v_mfma_f32_16x16x32_bf16 v[28:31], v[116:119], a[52:55], v[28:31]
  ds_read_b128 v[68:71], v10 offset:50176
  v_mfma_f32_16x16x32_bf16 v[32:35], v[120:123], a[48:51], v[32:35]
  v_mfma_f32_16x16x32_bf16 v[36:39], v[120:123], a[52:55], v[36:39]
  ds_read_b128 v[72:75], v10 offset:51200
  v_mfma_f32_16x16x32_bf16 v[40:43], v[124:127], a[48:51], v[40:43]
  v_mfma_f32_16x16x32_bf16 v[44:47], v[124:127], a[52:55], v[44:47]
  ds_read_b128 v[76:79], v10 offset:52224
  s_add_u32 s70, s73, 14
  s_and_b32 s70, s70, 15
  s_lshl_b32 s70, s70, 10
  s_add_u32 s70, s70, s69
  s_add_u32 m0, s72, 86016
  s_add_u32 s71, s70, 0
  buffer_load_dwordx4 v10, s[44:47], s71 offen sc1 lds
  v_mfma_f32_16x16x32_bf16 v[48:51], v[128:131], a[48:51], v[48:51]
  v_mfma_f32_16x16x32_bf16 v[52:55], v[128:131], a[52:55], v[52:55]
  ds_read_b128 v[80:83], v10 offset:53248
  v_mfma_f32_16x16x32_bf16 v[56:59], v[132:135], a[48:51], v[56:59]
  v_mfma_f32_16x16x32_bf16 v[60:63], v[132:135], a[52:55], v[60:63]
  ds_read_b128 v[84:87], v10 offset:54272
  v_mfma_f32_16x16x32_bf16 v[16:19], v[136:139], a[56:59], v[16:19]
  v_mfma_f32_16x16x32_bf16 v[20:23], v[136:139], a[60:63], v[20:23]
  ds_read_b128 v[88:91], v10 offset:55296
  v_mfma_f32_16x16x32_bf16 v[24:27], v[140:143], a[56:59], v[24:27]
  v_mfma_f32_16x16x32_bf16 v[28:31], v[140:143], a[60:63], v[28:31]
  ds_read_b128 v[92:95], v10 offset:56320
  s_add_u32 m0, s72, 87040
  s_add_u32 s71, s70, 16384
  buffer_load_dwordx4 v10, s[44:47], s71 offen sc1 lds
  v_mfma_f32_16x16x32_bf16 v[32:35], v[144:147], a[56:59], v[32:35]
  v_mfma_f32_16x16x32_bf16 v[36:39], v[144:147], a[60:63], v[36:39]
  ds_read_b128 v[96:99], v10 offset:57344
  v_mfma_f32_16x16x32_bf16 v[40:43], v[148:151], a[56:59], v[40:43]
  v_mfma_f32_16x16x32_bf16 v[44:47], v[148:151], a[60:63], v[44:47]
  ds_read_b128 v[100:103], v10 offset:58368
  v_mfma_f32_16x16x32_bf16 v[48:51], v[152:155], a[56:59], v[48:51]
  v_mfma_f32_16x16x32_bf16 v[52:55], v[152:155], a[60:63], v[52:55]
  ds_read_b128 v[104:107], v10 offset:59392
  v_mfma_f32_16x16x32_bf16 v[56:59], v[156:159], a[56:59], v[56:59]
  v_mfma_f32_16x16x32_bf16 v[60:63], v[156:159], a[60:63], v[60:63]
  ds_read_b128 v[108:111], v10 offset:60416
  s_add_u32 m0, s72, 88064
  s_add_u32 s71, s70, 32768
  buffer_load_dwordx4 v10, s[44:47], s71 offen sc1 lds
  s_waitcnt vmcnt(6)
  s_waitcnt lgkmcnt(0)
  s_barrier
  v_mfma_f32_16x16x32_bf16 v[16:19], v[64:67], a[64:67], v[16:19]
  v_mfma_f32_16x16x32_bf16 v[20:23], v[64:67], a[68:71], v[20:23]
  ds_read_b128 v[112:115], v10 offset:61440
  v_mfma_f32_16x16x32_bf16 v[24:27], v[68:71], a[64:67], v[24:27]
  v_mfma_f32_16x16x32_bf16 v[28:31], v[68:71], a[68:71], v[28:31]
  ds_read_b128 v[116:119], v10 offset:62464
  v_mfma_f32_16x16x32_bf16 v[32:35], v[72:75], a[64:67], v[32:35]
  v_mfma_f32_16x16x32_bf16 v[36:39], v[72:75], a[68:71], v[36:39]
  ds_read_b128 v[120:123], v10 offset:63488
  v_mfma_f32_16x16x32_bf16 v[40:43], v[76:79], a[64:67], v[40:43]
  v_mfma_f32_16x16x32_bf16 v[44:47], v[76:79], a[68:71], v[44:47]
  ds_read_b128 v[124:127], v10 offset:64512
  v_mfma_f32_16x16x32_bf16 v[48:51], v[80:83], a[64:67], v[48:51]
  v_mfma_f32_16x16x32_bf16 v[52:55], v[80:83], a[68:71], v[52:55]
  ds_read_b128 v[128:131], v11 offset:0
  v_mfma_f32_16x16x32_bf16 v[56:59], v[84:87], a[64:67], v[56:59]
  v_mfma_f32_16x16x32_bf16 v[60:63], v[84:87], a[68:71], v[60:63]
  ds_read_b128 v[132:135], v11 offset:1024
  v_mfma_f32_16x16x32_bf16 v[16:19], v[88:91], a[72:75], v[16:19]
  v_mfma_f32_16x16x32_bf16 v[20:23], v[88:91], a[76:79], v[20:23]
  ds_read_b128 v[136:139], v11 offset:2048
  v_mfma_f32_16x16x32_bf16 v[24:27], v[92:95], a[72:75], v[24:27]
  v_mfma_f32_16x16x32_bf16 v[28:31], v[92:95], a[76:79], v[28:31]
  ds_read_b128 v[140:143], v11 offset:3072
  v_mfma_f32_16x16x32_bf16 v[32:35], v[96:99], a[72:75], v[32:35]
  v_mfma_f32_16x16x32_bf16 v[36:39], v[96:99], a[76:79], v[36:39]
  ds_read_b128 v[144:147], v11 offset:4096
  v_mfma_f32_16x16x32_bf16 v[40:43], v[100:103], a[72:75], v[40:43]
  v_mfma_f32_16x16x32_bf16 v[44:47], v[100:103], a[76:79], v[44:47]
  ds_read_b128 v[148:151], v11 offset:5120
  v_mfma_f32_16x16x32_bf16 v[48:51], v[104:107], a[72:75], v[48:51]
  v_mfma_f32_16x16x32_bf16 v[52:55], v[104:107], a[76:79], v[52:55]
  ds_read_b128 v[152:155], v11 offset:6144
  v_mfma_f32_16x16x32_bf16 v[56:59], v[108:111], a[72:75], v[56:59]
  v_mfma_f32_16x16x32_bf16 v[60:63], v[108:111], a[76:79], v[60:63]
  ds_read_b128 v[156:159], v11 offset:7168
  s_waitcnt vmcnt(3)
  s_waitcnt lgkmcnt(0)
  s_barrier
  v_mfma_f32_16x16x32_bf16 v[16:19], v[112:115], a[80:83], v[16:19]
  v_mfma_f32_16x16x32_bf16 v[20:23], v[112:115], a[84:87], v[20:23]
  ds_read_b128 v[64:67], v11 offset:8192
  v_mfma_f32_16x16x32_bf16 v[24:27], v[116:119], a[80:83], v[24:27]
  v_mfma_f32_16x16x32_bf16 v[28:31], v[116:119], a[84:87], v[28:31]
  ds_read_b128 v[68:71], v11 offset:9216
  v_mfma_f32_16x16x32_bf16 v[32:35], v[120:123], a[80:83], v[32:35]
  v_mfma_f32_16x16x32_bf16 v[36:39], v[120:123], a[84:87], v[36:39]
  ds_read_b128 v[72:75], v11 offset:10240
  v_mfma_f32_16x16x32_bf16 v[40:43], v[124:127], a[80:83], v[40:43]
  v_mfma_f32_16x16x32_bf16 v[44:47], v[124:127], a[84:87], v[44:47]
  ds_read_b128 v[76:79], v11 offset:11264
  v_mfma_f32_16x16x32_bf16 v[48:51], v[128:131], a[80:83], v[48:51]
  v_mfma_f32_16x16x32_bf16 v[52:55], v[128:131], a[84:87], v[52:55]
  ds_read_b128 v[80:83], v11 offset:12288
  v_mfma_f32_16x16x32_bf16 v[56:59], v[132:135], a[80:83], v[56:59]
  v_mfma_f32_16x16x32_bf16 v[60:63], v[132:135], a[84:87], v[60:63]
  ds_read_b128 v[84:87], v11 offset:13312
  v_mfma_f32_16x16x32_bf16 v[16:19], v[136:139], a[88:91], v[16:19]
  v_mfma_f32_16x16x32_bf16 v[20:23], v[136:139], a[92:95], v[20:23]
  ds_read_b128 v[88:91], v11 offset:14336
  v_mfma_f32_16x16x32_bf16 v[24:27], v[140:143], a[88:91], v[24:27]
  v_mfma_f32_16x16x32_bf16 v[28:31], v[140:143], a[92:95], v[28:31]
  ds_read_b128 v[92:95], v11 offset:15360
  v_mfma_f32_16x16x32_bf16 v[32:35], v[144:147], a[88:91], v[32:35]
  v_mfma_f32_16x16x32_bf16 v[36:39], v[144:147], a[92:95], v[36:39]
  ds_read_b128 v[96:99], v11 offset:16384
  v_mfma_f32_16x16x32_bf16 v[40:43], v[148:151], a[88:91], v[40:43]
  v_mfma_f32_16x16x32_bf16 v[44:47], v[148:151], a[92:95], v[44:47]
  ds_read_b128 v[100:103], v11 offset:17408
  v_mfma_f32_16x16x32_bf16 v[48:51], v[152:155], a[88:91], v[48:51]
  v_mfma_f32_16x16x32_bf16 v[52:55], v[152:155], a[92:95], v[52:55]
  ds_read_b128 v[104:107], v11 offset:18432
  v_mfma_f32_16x16x32_bf16 v[56:59], v[156:159], a[88:91], v[56:59]
  v_mfma_f32_16x16x32_bf16 v[60:63], v[156:159], a[92:95], v[60:63]
  ds_read_b128 v[108:111], v11 offset:19456
  s_waitcnt vmcnt(0)
  s_waitcnt lgkmcnt(0)
  s_barrier
  v_mfma_f32_16x16x32_bf16 v[16:19], v[64:67], a[96:99], v[16:19]
  v_mfma_f32_16x16x32_bf16 v[20:23], v[64:67], a[100:103], v[20:23]
  ds_read_b128 v[112:115], v11 offset:20480
  v_mfma_f32_16x16x32_bf16 v[24:27], v[68:71], a[96:99], v[24:27]
  v_mfma_f32_16x16x32_bf16 v[28:31], v[68:71], a[100:103], v[28:31]
  ds_read_b128 v[116:119], v11 offset:21504
  v_mfma_f32_16x16x32_bf16 v[32:35], v[72:75], a[96:99], v[32:35]
  v_mfma_f32_16x16x32_bf16 v[36:39], v[72:75], a[100:103], v[36:39]
  ds_read_b128 v[120:123], v11 offset:22528
  v_mfma_f32_16x16x32_bf16 v[40:43], v[76:79], a[96:99], v[40:43]
  v_mfma_f32_16x16x32_bf16 v[44:47], v[76:79], a[100:103], v[44:47]
  ds_read_b128 v[124:127], v11 offset:23552
  v_mfma_f32_16x16x32_bf16 v[48:51], v[80:83], a[96:99], v[48:51]
  v_mfma_f32_16x16x32_bf16 v[52:55], v[80:83], a[100:103], v[52:55]
  ds_read_b128 v[128:131], v11 offset:24576
  v_mfma_f32_16x16x32_bf16 v[56:59], v[84:87], a[96:99], v[56:59]
  v_mfma_f32_16x16x32_bf16 v[60:63], v[84:87], a[100:103], v[60:63]
  ds_read_b128 v[132:135], v11 offset:25600
  v_mfma_f32_16x16x32_bf16 v[16:19], v[88:91], a[104:107], v[16:19]
  v_mfma_f32_16x16x32_bf16 v[20:23], v[88:91], a[108:111], v[20:23]
  ds_read_b128 v[136:139], v11 offset:26624
  v_mfma_f32_16x16x32_bf16 v[24:27], v[92:95], a[104:107], v[24:27]
  v_mfma_f32_16x16x32_bf16 v[28:31], v[92:95], a[108:111], v[28:31]
  ds_read_b128 v[140:143], v11 offset:27648
  v_mfma_f32_16x16x32_bf16 v[32:35], v[96:99], a[104:107], v[32:35]
  v_mfma_f32_16x16x32_bf16 v[36:39], v[96:99], a[108:111], v[36:39]
  ds_read_b128 v[144:147], v11 offset:28672
  v_mfma_f32_16x16x32_bf16 v[40:43], v[100:103], a[104:107], v[40:43]
  v_mfma_f32_16x16x32_bf16 v[44:47], v[100:103], a[108:111], v[44:47]
  ds_read_b128 v[148:151], v11 offset:29696
  v_mfma_f32_16x16x32_bf16 v[48:51], v[104:107], a[104:107], v[48:51]
  v_mfma_f32_16x16x32_bf16 v[52:55], v[104:107], a[108:111], v[52:55]
  ds_read_b128 v[152:155], v11 offset:30720
  v_mfma_f32_16x16x32_bf16 v[56:59], v[108:111], a[104:107], v[56:59]
  v_mfma_f32_16x16x32_bf16 v[60:63], v[108:111], a[108:111], v[60:63]
  ds_read_b128 v[156:159], v11 offset:31744
  s_waitcnt lgkmcnt(0)
  v_mfma_f32_16x16x32_bf16 v[16:19], v[112:115], a[112:115], v[16:19]
  v_mfma_f32_16x16x32_bf16 v[20:23], v[112:115], a[116:119], v[20:23]
  v_mfma_f32_16x16x32_bf16 v[24:27], v[116:119], a[112:115], v[24:27]
  v_mfma_f32_16x16x32_bf16 v[28:31], v[116:119], a[116:119], v[28:31]
  v_mfma_f32_16x16x32_bf16 v[32:35], v[120:123], a[112:115], v[32:35]
  v_mfma_f32_16x16x32_bf16 v[36:39], v[120:123], a[116:119], v[36:39]
  v_mfma_f32_16x16x32_bf16 v[40:43], v[124:127], a[112:115], v[40:43]
  v_mfma_f32_16x16x32_bf16 v[44:47], v[124:127], a[116:119], v[44:47]
  v_mfma_f32_16x16x32_bf16 v[48:51], v[128:131], a[112:115], v[48:51]
  v_mfma_f32_16x16x32_bf16 v[52:55], v[128:131], a[116:119], v[52:55]
  v_mfma_f32_16x16x32_bf16 v[56:59], v[132:135], a[112:115], v[56:59]
  v_mfma_f32_16x16x32_bf16 v[60:63], v[132:135], a[116:119], v[60:63]
  v_mfma_f32_16x16x32_bf16 v[16:19], v[136:139], a[120:123], v[16:19]
  v_mfma_f32_16x16x32_bf16 v[20:23], v[136:139], a[124:127], v[20:23]
  v_mfma_f32_16x16x32_bf16 v[24:27], v[140:143], a[120:123], v[24:27]
  v_mfma_f32_16x16x32_bf16 v[28:31], v[140:143], a[124:127], v[28:31]
  v_mfma_f32_16x16x32_bf16 v[32:35], v[144:147], a[120:123], v[32:35]
  v_mfma_f32_16x16x32_bf16 v[36:39], v[144:147], a[124:127], v[36:39]
  v_mfma_f32_16x16x32_bf16 v[40:43], v[148:151], a[120:123], v[40:43]
  v_mfma_f32_16x16x32_bf16 v[44:47], v[148:151], a[124:127], v[44:47]
  v_mfma_f32_16x16x32_bf16 v[48:51], v[152:155], a[120:123], v[48:51]
  v_mfma_f32_16x16x32_bf16 v[52:55], v[152:155], a[124:127], v[52:55]
  v_mfma_f32_16x16x32_bf16 v[56:59], v[156:159], a[120:123], v[56:59]
  v_mfma_f32_16x16x32_bf16 v[60:63], v[156:159], a[124:127], v[60:63]
  s_nop 7
  s_nop 1
  v_and_b32 v1, 15, v0
  v_lshrrev_b32 v2, 4, v0
  v_mul_u32_u24 v3, 2752, v1
  v_lshl_add_u32 v3, v2, 4, v3
  s_lshl_b32 s70, s60, 7
  s_lshl_b32 s71, s56, 5
  s_add_u32 s70, s70, s71
  s_mul_i32 s70, s70, 2752
  s_mul_i32 s71, s61, 192
  s_add_u32 s70, s70, s71
  s_add_u32 s71, s70, 44032
  v_cvt_pk_bf16_f32 v160, v16, v17
  v_cvt_pk_bf16_f32 v161, v18, v19
  v_cvt_pk_bf16_f32 v162, v24, v25
  v_cvt_pk_bf16_f32 v163, v26, v27
  buffer_store_dwordx4 v[160:163], v3, s[32:35], s70 offen offset:0 nt
  v_cvt_pk_bf16_f32 v164, v20, v21
  v_cvt_pk_bf16_f32 v165, v22, v23
  v_cvt_pk_bf16_f32 v166, v28, v29
  v_cvt_pk_bf16_f32 v167, v30, v31
  buffer_store_dwordx4 v[164:167], v3, s[32:35], s71 offen offset:0 nt
  s_cmp_eq_u32 s61, 14
  s_cbranch_scc1 Y_done
  v_cvt_pk_bf16_f32 v168, v32, v33
  v_cvt_pk_bf16_f32 v169, v34, v35
  v_cvt_pk_bf16_f32 v170, v40, v41
  v_cvt_pk_bf16_f32 v171, v42, v43
  buffer_store_dwordx4 v[168:171], v3, s[32:35], s70 offen offset:64 nt
  v_cvt_pk_bf16_f32 v172, v36, v37
  v_cvt_pk_bf16_f32 v173, v38, v39
  v_cvt_pk_bf16_f32 v174, v44, v45
  v_cvt_pk_bf16_f32 v175, v46, v47
  buffer_store_dwordx4 v[172:175], v3, s[32:35], s71 offen offset:64 nt
  v_cvt_pk_bf16_f32 v176, v48, v49
  v_cvt_pk_bf16_f32 v177, v50, v51
  v_cvt_pk_bf16_f32 v178, v56, v57
  v_cvt_pk_bf16_f32 v179, v58, v59
  buffer_store_dwordx4 v[176:179], v3, s[32:35], s70 offen offset:128 nt
  v_cvt_pk_bf16_f32 v180, v52, v53
  v_cvt_pk_bf16_f32 v181, v54, v55
  v_cvt_pk_bf16_f32 v182, v60, v61
  v_cvt_pk_bf16_f32 v183, v62, v63
  buffer_store_dwordx4 v[180:183], v3, s[32:35], s71 offen offset:128 nt
Y_done:
K_fin:
K_end:
  s_endpgm
K_notT:
  s_sub_u32 s63, s63, s65
  s_cmp_lt_u32 s63, 8
  s_cbranch_scc0 K_spare
  s_and_b32 s64, s62, 1
  s_lshl_b32 s64, s64, 1
  s_and_b32 s65, s63, 1
  s_add_u32 s58, s64, s65
  s_lshr_b32 s64, s62, 1
  s_lshl_b32 s64, s64, 2
  s_lshr_b32 s65, s63, 1
  s_add_u32 s59, s64, s65
  s_and_b32 s64, s63, 1
  s_lshl_b32 s64, s64, 2
  s_lshr_b32 s65, s63, 1
  s_lshl_b32 s65, s65, 1
  s_add_u32 s73, s64, s65
  s_and_b32 s64, s62, 1
  s_add_u32 s73, s73, s64
  s_and_b32 s64, s56, 1
  s_lshr_b32 s65, s56, 1
  v_lshrrev_b32 v1, 4, v0
  v_and_b32 v2, 15, v0
  v_lshlrev_b32 v3, 1, v1
  v_xor_b32 v4, v2, v3
  v_xor_b32 v5, 8, v4
  v_lshlrev_b32 v6, 10, v1
  v_lshl_add_u32 v10, v4, 4, v6
  v_lshl_add_u32 v11, v5, 4, v6
  v_lshrrev_b32 v1, 3, v0
  v_and_b32 v2, 7, v0
  v_lshrrev_b32 v3, 1, v1
  v_xor_b32 v4, v2, v3
  v_xor_b32 v5, 4, v4
  v_lshlrev_b32 v6, 10, v1
  v_lshl_add_u32 v12, v4, 4, v6
  v_lshl_add_u32 v13, v5, 4, v6
  s_lshl_b32 s66, s56, 14
  s_lshl_b32 s69, s58, 8
  s_add_u32 s66, s66, s69
  s_lshl_b32 s67, s59, 17
  s_lshl_b32 s69, s56, 15
  s_add_u32 s67, s67, s69
  s_lshl_b32 s68, s56, 12
  s_waitcnt lgkmcnt(0)
  s_add_u32 s70, s73, 0
  s_and_b32 s70, s70, 7
  s_lshl_b32 s71, s70, 16
  s_add_u32 s71, s71, s66
  s_lshl_b32 s72, s70, 7
  s_add_u32 s72, s72, s67
  s_add_u32 m0, s68, 0
  s_add_u32 s69, s71, 0
  buffer_load_dwordx4 v10, s[24:27], s69 offen lds
  s_add_u32 m0, s68, 1024
  s_add_u32 s69, s71, 4096
  buffer_load_dwordx4 v10, s[24:27], s69 offen lds
  s_add_u32 m0, s68, 2048
  s_add_u32 s69, s71, 8192
  buffer_load_dwordx4 v11, s[24:27], s69 offen lds
  s_add_u32 m0, s68, 3072
  s_add_u32 s69, s71, 12288
  buffer_load_dwordx4 v11, s[24:27], s69 offen lds
  s_add_u32 m0, s68, 16384
  s_add_u32 s69, s72, 0
  buffer_load_dwordx4 v12, s[8:11], s69 offen lds
  s_add_u32 m0, s68, 17408
  s_add_u32 s69, s72, 8192
  buffer_load_dwordx4 v13, s[8:11], s69 offen lds
  s_add_u32 m0, s68, 18432
  s_add_u32 s69, s72, 16384
  buffer_load_dwordx4 v12, s[8:11], s69 offen lds
  s_add_u32 m0, s68, 19456
  s_add_u32 s69, s72, 24576
  buffer_load_dwordx4 v13, s[8:11], s69 offen lds
  s_add_u32 s70, s73, 1
  s_and_b32 s70, s70, 7
  s_lshl_b32 s71, s70, 16
  s_add_u32 s71, s71, s66
  s_lshl_b32 s72, s70, 7
  s_add_u32 s72, s72, s67
  s_add_u32 m0, s68, 32768
  s_add_u32 s69, s71, 0
  buffer_load_dwordx4 v10, s[24:27], s69 offen lds
  s_add_u32 m0, s68, 33792
  s_add_u32 s69, s71, 4096
  buffer_load_dwordx4 v10, s[24:27], s69 offen lds
  s_add_u32 m0, s68, 34816
  s_add_u32 s69, s71, 8192
  buffer_load_dwordx4 v11, s[24:27], s69 offen lds
  s_add_u32 m0, s68, 35840
  s_add_u32 s69, s71, 12288
  buffer_load_dwordx4 v11, s[24:27], s69 offen lds
  s_add_u32 s36, s92, 0
  s_addc_u32 s37, s93, 0
  s_add_u32 s48, s92, 6291456
  s_addc_u32 s49, s93, 0
  s_add_u32 s40, s92, 2097152
  s_addc_u32 s41, s93, 0
  s_add_u32 s44, s92, 4194304
  s_addc_u32 s45, s93, 0
  v_lshrrev_b32 v1, 4, v0
  v_bfe_u32 v2, v0, 2, 2
  v_and_b32 v3, 3, v0
  v_lshl_add_u32 v4, v1, 3, v2
  v_lshlrev_b32 v4, 8, v4
  v_and_b32 v5, 1, v1
  v_lshlrev_b32 v5, 3, v5
  v_lshl_add_u32 v5, v2, 1, v5
  v_lshrrev_b32 v6, 1, v3
  s_lshl_b32 s69, s64, 3
  v_or_b32 v6, s69, v6
  v_xor_b32 v5, v5, v6
  v_lshl_add_u32 v4, v5, 4, v4
  v_and_b32 v6, 1, v3
  v_lshl_add_u32 v4, v6, 3, v4
  v_xor_b32 v16, 0, v4
  v_add_u32 v20, 0x10000, v16
  v_xor_b32 v17, 32, v4
  v_add_u32 v21, 0x10000, v17
  v_xor_b32 v18, 64, v4
  v_add_u32 v22, 0x10000, v18
  v_xor_b32 v19, 96, v4
  v_add_u32 v23, 0x10000, v19
  v_and_b32 v2, 15, v0
  v_lshrrev_b32 v3, 1, v2
  v_xor_b32 v3, v3, v1
  v_lshlrev_b32 v4, 7, v2
  v_lshl_add_u32 v4, v3, 4, v4
  s_lshl_b32 s69, s65, 13
  s_add_u32 s69, s69, 16384
  v_add_u32 v24, s69, v4
  v_xor_b32 v25, 64, v24
  v_add_u32 v26, 0x10000, v24
  v_add_u32 v27, 0x10000, v25
  v_mov_b32 v64, 0
  v_mov_b32 v65, 0
  v_mov_b32 v66, 0
  v_mov_b32 v67, 0
  v_mov_b32 v68, 0
  v_mov_b32 v69, 0
  v_mov_b32 v70, 0
  v_mov_b32 v71, 0
  v_mov_b32 v72, 0
  v_mov_b32 v73, 0
  v_mov_b32 v74, 0
  v_mov_b32 v75, 0
  v_mov_b32 v76, 0
  v_mov_b32 v77, 0
  v_mov_b32 v78, 0
  v_mov_b32 v79, 0
  v_mov_b32 v80, 0
  v_mov_b32 v81, 0
  v_mov_b32 v82, 0
  v_mov_b32 v83, 0
  v_mov_b32 v84, 0
  v_mov_b32 v85, 0
  v_mov_b32 v86, 0
  v_mov_b32 v87, 0
  v_mov_b32 v88, 0
  v_mov_b32 v89, 0
  v_mov_b32 v90, 0
  v_mov_b32 v91, 0
  v_mov_b32 v92, 0
  v_mov_b32 v93, 0
  v_mov_b32 v94, 0
  v_mov_b32 v95, 0
  v_mov_b32 v96, 0
  v_mov_b32 v97, 0
  v_mov_b32 v98, 0
  v_mov_b32 v99, 0
  v_mov_b32 v100, 0
  v_mov_b32 v101, 0
  v_mov_b32 v102, 0
  v_mov_b32 v103, 0
  v_mov_b32 v104, 0
  v_mov_b32 v105, 0
  v_mov_b32 v106, 0
  v_mov_b32 v107, 0
  v_mov_b32 v108, 0
  v_mov_b32 v109, 0
  v_mov_b32 v110, 0
  v_mov_b32 v111, 0
  v_mov_b32 v112, 0
  v_mov_b32 v113, 0
  v_mov_b32 v114, 0
  v_mov_b32 v115, 0
  v_mov_b32 v116, 0
  v_mov_b32 v117, 0
  v_mov_b32 v118, 0
  v_mov_b32 v119, 0
  v_mov_b32 v120, 0
  v_mov_b32 v121, 0
  v_mov_b32 v122, 0
  v_mov_b32 v123, 0
  v_mov_b32 v124, 0
  v_mov_b32 v125, 0
  v_mov_b32 v126, 0
  v_mov_b32 v127, 0
  s_waitcnt vmcnt(4)
  s_barrier
  ds_read_b128 v[144:147], v24 offset:0
  ds_read_b128 v[148:151], v24 offset:2048
  ds_read_b128 v[152:155], v24 offset:4096
  ds_read_b128 v[156:159], v24 offset:6144
  ds_read_b64_tr_b16 v[128:129], v16 offset:0
  ds_read_b64_tr_b16 v[130:131], v16 offset:1024
  ds_read_b64_tr_b16 v[132:133], v17 offset:0
  ds_read_b64_tr_b16 v[134:135], v17 offset:1024
  ds_read_b64_tr_b16 v[136:137], v18 offset:0
  ds_read_b64_tr_b16 v[138:139], v18 offset:1024
  ds_read_b64_tr_b16 v[140:141], v19 offset:0
  ds_read_b64_tr_b16 v[142:143], v19 offset:1024
  s_waitcnt lgkmcnt(0)
  v_mfma_f32_16x16x32_bf16 v[64:67], v[128:131], v[144:147], v[64:67]
  v_mfma_f32_16x16x32_bf16 v[68:71], v[128:131], v[148:151], v[68:71]
  ds_read_b128 v[176:179], v25 offset:0
  s_add_u32 m0, s68, 49152
  s_add_u32 s69, s72, 0
  buffer_load_dwordx4 v12, s[8:11], s69 offen lds
  v_mfma_f32_16x16x32_bf16 v[72:75], v[128:131], v[152:155], v[72:75]
  ds_read_b128 v[180:183], v25 offset:2048
  s_add_u32 m0, s68, 50176
  s_add_u32 s69, s72, 8192
  buffer_load_dwordx4 v13, s[8:11], s69 offen lds
  v_mfma_f32_16x16x32_bf16 v[76:79], v[128:131], v[156:159], v[76:79]
  ds_read_b128 v[184:187], v25 offset:4096
  s_add_u32 m0, s68, 51200
  s_add_u32 s69, s72, 16384
  buffer_load_dwordx4 v12, s[8:11], s69 offen lds
  v_mfma_f32_16x16x32_bf16 v[80:83], v[132:135], v[144:147], v[80:83]
  v_mfma_f32_16x16x32_bf16 v[84:87], v[132:135], v[148:151], v[84:87]
  ds_read_b128 v[188:191], v25 offset:6144
  s_add_u32 m0, s68, 52224
  s_add_u32 s69, s72, 24576
  buffer_load_dwordx4 v13, s[8:11], s69 offen lds
  v_mfma_f32_16x16x32_bf16 v[88:91], v[132:135], v[152:155], v[88:91]
  ds_read_b64_tr_b16 v[160:161], v16 offset:8192
  s_add_u32 s70, s73, 2
  s_and_b32 s70, s70, 7
  s_lshl_b32 s71, s70, 16
  s_add_u32 s71, s71, s66
  s_lshl_b32 s72, s70, 7
  s_add_u32 s72, s72, s67
  s_add_u32 m0, s68, 65536
  s_add_u32 s69, s71, 0
  buffer_load_dwordx4 v10, s[24:27], s69 offen lds
  v_mfma_f32_16x16x32_bf16 v[92:95], v[132:135], v[156:159], v[92:95]
  ds_read_b64_tr_b16 v[162:163], v16 offset:9216
  s_add_u32 m0, s68, 66560
  s_add_u32 s69, s71, 4096
  buffer_load_dwordx4 v10, s[24:27], s69 offen lds
  v_mfma_f32_16x16x32_bf16 v[96:99], v[136:139], v[144:147], v[96:99]
  v_mfma_f32_16x16x32_bf16 v[100:103], v[136:139], v[148:151], v[100:103]
  ds_read_b64_tr_b16 v[164:165], v17 offset:8192
  s_add_u32 m0, s68, 67584
  s_add_u32 s69, s71, 8192
  buffer_load_dwordx4 v11, s[24:27], s69 offen lds
  v_mfma_f32_16x16x32_bf16 v[104:107], v[136:139], v[152:155], v[104:107]
  ds_read_b64_tr_b16 v[166:167], v17 offset:9216
  s_add_u32 m0, s68, 68608
  s_add_u32 s69, s71, 12288
  buffer_load_dwordx4 v11, s[24:27], s69 offen lds
  v_mfma_f32_16x16x32_bf16 v[108:111], v[136:139], v[156:159], v[108:111]
  ds_read_b64_tr_b16 v[168:169], v18 offset:8192
  s_add_u32 m0, s68, 81920
  s_add_u32 s69, s72, 0
  buffer_load_dwordx4 v12, s[8:11], s69 offen lds
  v_mfma_f32_16x16x32_bf16 v[112:115], v[140:143], v[144:147], v[112:115]
  v_mfma_f32_16x16x32_bf16 v[116:119], v[140:143], v[148:151], v[116:119]
  ds_read_b64_tr_b16 v[170:171], v18 offset:9216
  s_add_u32 m0, s68, 82944
  s_add_u32 s69, s72, 8192
  buffer_load_dwordx4 v13, s[8:11], s69 offen lds
  v_mfma_f32_16x16x32_bf16 v[120:123], v[140:143], v[152:155], v[120:123]
  ds_read_b64_tr_b16 v[172:173], v19 offset:8192
  s_add_u32 m0, s68, 83968
  s_add_u32 s69, s72, 16384
  buffer_load_dwordx4 v12, s[8:11], s69 offen lds
  v_mfma_f32_16x16x32_bf16 v[124:127], v[140:143], v[156:159], v[124:127]
  ds_read_b64_tr_b16 v[174:175], v19 offset:9216
  s_add_u32 m0, s68, 84992
  s_add_u32 s69, s72, 24576
  buffer_load_dwordx4 v13, s[8:11], s69 offen lds
  s_waitcnt lgkmcnt(0)
  s_waitcnt vmcnt(8)
  s_barrier
  v_mfma_f32_16x16x32_bf16 v[64:67], v[160:163], v[176:179], v[64:67]
  v_mfma_f32_16x16x32_bf16 v[68:71], v[160:163], v[180:183], v[68:71]
  ds_read_b128 v[144:147], v24 offset:32768
  v_mfma_f32_16x16x32_bf16 v[72:75], v[160:163], v[184:187], v[72:75]
  ds_read_b128 v[148:151], v24 offset:34816
  v_mfma_f32_16x16x32_bf16 v[76:79], v[160:163], v[188:191], v[76:79]
  ds_read_b128 v[152:155], v24 offset:36864
  s_add_u32 s70, s73, 3
  s_and_b32 s70, s70, 7
  s_lshl_b32 s71, s70, 16
  s_add_u32 s71, s71, s66
  s_lshl_b32 s72, s70, 7
  s_add_u32 s72, s72, s67
  s_add_u32 m0, s68, 98304
  s_add_u32 s69, s71, 0
  buffer_load_dwordx4 v10, s[24:27], s69 offen lds
  v_mfma_f32_16x16x32_bf16 v[80:83], v[164:167], v[176:179], v[80:83]
  v_mfma_f32_16x16x32_bf16 v[84:87], v[164:167], v[180:183], v[84:87]
  ds_read_b128 v[156:159], v24 offset:38912
  v_mfma_f32_16x16x32_bf16 v[88:91], v[164:167], v[184:187], v[88:91]
  ds_read_b64_tr_b16 v[128:129], v16 offset:32768
  v_mfma_f32_16x16x32_bf16 v[92:95], v[164:167], v[188:191], v[92:95]
  ds_read_b64_tr_b16 v[130:131], v16 offset:33792
  s_add_u32 m0, s68, 99328
  s_add_u32 s69, s71, 4096
  buffer_load_dwordx4 v10, s[24:27], s69 offen lds
  v_mfma_f32_16x16x32_bf16 v[96:99], v[168:171], v[176:179], v[96:99]
  v_mfma_f32_16x16x32_bf16 v[100:103], v[168:171], v[180:183], v[100:103]
  ds_read_b64_tr_b16 v[132:133], v17 offset:32768
  v_mfma_f32_16x16x32_bf16 v[104:107], v[168:171], v[184:187], v[104:107]
  ds_read_b64_tr_b16 v[134:135], v17 offset:33792
  v_mfma_f32_16x16x32_bf16 v[108:111], v[168:171], v[188:191], v[108:111]
  ds_read_b64_tr_b16 v[136:137], v18 offset:32768
  s_add_u32 m0, s68, 100352
  s_add_u32 s69, s71, 8192
  buffer_load_dwordx4 v11, s[24:27], s69 offen lds
  v_mfma_f32_16x16x32_bf16 v[112:115], v[172:175], v[176:179], v[112:115]
  v_mfma_f32_16x16x32_bf16 v[116:119], v[172:175], v[180:183], v[116:119]
  ds_read_b64_tr_b16 v[138:139], v18 offset:33792
  v_mfma_f32_16x16x32_bf16 v[120:123], v[172:175], v[184:187], v[120:123]
  ds_read_b64_tr_b16 v[140:141], v19 offset:32768
  v_mfma_f32_16x16x32_bf16 v[124:127], v[172:175], v[188:191], v[124:127]
  ds_read_b64_tr_b16 v[142:143], v19 offset:33792
  s_add_u32 m0, s68, 101376
  s_add_u32 s69, s71, 12288
  buffer_load_dwordx4 v11, s[24:27], s69 offen lds
  s_waitcnt lgkmcnt(0)
  v_mfma_f32_16x16x32_bf16 v[64:67], v[128:131], v[144:147], v[64:67]
  v_mfma_f32_16x16x32_bf16 v[68:71], v[128:131], v[148:151], v[68:71]
  ds_read_b128 v[176:179], v25 offset:32768
  v_mfma_f32_16x16x32_bf16 v[72:75], v[128:131], v[152:155], v[72:75]
  ds_read_b128 v[180:183], v25 offset:34816
  v_mfma_f32_16x16x32_bf16 v[76:79], v[128:131], v[156:159], v[76:79]
  ds_read_b128 v[184:187], v25 offset:36864
  s_add_u32 m0, s68, 114688
  s_add_u32 s69, s72, 0
  buffer_load_dwordx4 v12, s[8:11], s69 offen lds
  v_mfma_f32_16x16x32_bf16 v[80:83], v[132:135], v[144:147], v[80:83]
  v_mfma_f32_16x16x32_bf16 v[84:87], v[132:135], v[148:151], v[84:87]
  ds_read_b128 v[188:191], v25 offset:38912
  v_mfma_f32_16x16x32_bf16 v[88:91], v[132:135], v[152:155], v[88:91]
  ds_read_b64_tr_b16 v[160:161], v16 offset:40960
  v_mfma_f32_16x16x32_bf16 v[92:95], v[132:135], v[156:159], v[92:95]
  ds_read_b64_tr_b16 v[162:163], v16 offset:41984
  s_add_u32 m0, s68, 115712
  s_add_u32 s69, s72, 8192
  buffer_load_dwordx4 v13, s[8:11], s69 offen lds
  v_mfma_f32_16x16x32_bf16 v[96:99], v[136:139], v[144:147], v[96:99]
  v_mfma_f32_16x16x32_bf16 v[100:103], v[136:139], v[148:151], v[100:103]
  ds_read_b64_tr_b16 v[164:165], v17 offset:40960
  v_mfma_f32_16x16x32_bf16 v[104:107], v[136:139], v[152:155], v[104:107]
  ds_read_b64_tr_b16 v[166:167], v17 offset:41984
  v_mfma_f32_16x16x32_bf16 v[108:111], v[136:139], v[156:159], v[108:111]
  ds_read_b64_tr_b16 v[168:169], v18 offset:40960
  s_add_u32 m0, s68, 116736
  s_add_u32 s69, s72, 16384
  buffer_load_dwordx4 v12, s[8:11], s69 offen lds
  v_mfma_f32_16x16x32_bf16 v[112:115], v[140:143], v[144:147], v[112:115]
  v_mfma_f32_16x16x32_bf16 v[116:119], v[140:143], v[148:151], v[116:119]
  ds_read_b64_tr_b16 v[170:171], v18 offset:41984
  v_mfma_f32_16x16x32_bf16 v[120:123], v[140:143], v[152:155], v[120:123]
  ds_read_b64_tr_b16 v[172:173], v19 offset:40960
  v_mfma_f32_16x16x32_bf16 v[124:127], v[140:143], v[156:159], v[124:127]
  ds_read_b64_tr_b16 v[174:175], v19 offset:41984
  s_add_u32 m0, s68, 117760
  s_add_u32 s69, s72, 24576
  buffer_load_dwordx4 v13, s[8:11], s69 offen lds
  s_waitcnt lgkmcnt(0)
  s_waitcnt vmcnt(8)
  s_barrier
  v_mfma_f32_16x16x32_bf16 v[64:67], v[160:163], v[176:179], v[64:67]
  v_mfma_f32_16x16x32_bf16 v[68:71], v[160:163], v[180:183], v[68:71]
  ds_read_b128 v[144:147], v26 offset:0
  v_mfma_f32_16x16x32_bf16 v[72:75], v[160:163], v[184:187], v[72:75]
  ds_read_b128 v[148:151], v26 offset:2048
  v_mfma_f32_16x16x32_bf16 v[76:79], v[160:163], v[188:191], v[76:79]
  ds_read_b128 v[152:155], v26 offset:4096
  s_add_u32 s70, s73, 4
  s_and_b32 s70, s70, 7
  s_lshl_b32 s71, s70, 16
  s_add_u32 s71, s71, s66
  s_lshl_b32 s72, s70, 7
  s_add_u32 s72, s72, s67
  s_add_u32 m0, s68, 0
  s_add_u32 s69, s71, 0
  buffer_load_dwordx4 v10, s[24:27], s69 offen lds
  v_mfma_f32_16x16x32_bf16 v[80:83], v[164:167], v[176:179], v[80:83]
  v_mfma_f32_16x16x32_bf16 v[84:87], v[164:167], v[180:183], v[84:87]
  ds_read_b128 v[156:159], v26 offset:6144
  v_mfma_f32_16x16x32_bf16 v[88:91], v[164:167], v[184:187], v[88:91]
  ds_read_b64_tr_b16 v[128:129], v20 offset:0
  v_mfma_f32_16x16x32_bf16 v[92:95], v[164:167], v[188:191], v[92:95]
  ds_read_b64_tr_b16 v[130:131], v20 offset:1024
  s_add_u32 m0, s68, 1024
  s_add_u32 s69, s71, 4096
  buffer_load_dwordx4 v10, s[24:27], s69 offen lds
  v_mfma_f32_16x16x32_bf16 v[96:99], v[168:171], v[176:179], v[96:99]
  v_mfma_f32_16x16x32_bf16 v[100:103], v[168:171], v[180:183], v[100:103]
  ds_read_b64_tr_b16 v[132:133], v21 offset:0
  v_mfma_f32_16x16x32_bf16 v[104:107], v[168:171], v[184:187], v[104:107]
  ds_read_b64_tr_b16 v[134:135], v21 offset:1024
  v_mfma_f32_16x16x32_bf16 v[108:111], v[168:171], v[188:191], v[108:111]
  ds_read_b64_tr_b16 v[136:137], v22 offset:0
  s_add_u32 m0, s68, 2048
  s_add_u32 s69, s71, 8192
  buffer_load_dwordx4 v11, s[24:27], s69 offen lds
  v_mfma_f32_16x16x32_bf16 v[112:115], v[172:175], v[176:179], v[112:115]
  v_mfma_f32_16x16x32_bf16 v[116:119], v[172:175], v[180:183], v[116:119]
  ds_read_b64_tr_b16 v[138:139], v22 offset:1024
  v_mfma_f32_16x16x32_bf16 v[120:123], v[172:175], v[184:187], v[120:123]
  ds_read_b64_tr_b16 v[140:141], v23 offset:0
  v_mfma_f32_16x16x32_bf16 v[124:127], v[172:175], v[188:191], v[124:127]
  ds_read_b64_tr_b16 v[142:143], v23 offset:1024
  s_add_u32 m0, s68, 3072
  s_add_u32 s69, s71, 12288
  buffer_load_dwordx4 v11, s[24:27], s69 offen lds
  s_waitcnt lgkmcnt(0)
  v_mfma_f32_16x16x32_bf16 v[64:67], v[128:131], v[144:147], v[64:67]
  v_mfma_f32_16x16x32_bf16 v[68:71], v[128:131], v[148:151], v[68:71]
  ds_read_b128 v[176:179], v27 offset:0
  v_mfma_f32_16x16x32_bf16 v[72:75], v[128:131], v[152:155], v[72:75]
  ds_read_b128 v[180:183], v27 offset:2048
  v_mfma_f32_16x16x32_bf16 v[76:79], v[128:131], v[156:159], v[76:79]
  ds_read_b128 v[184:187], v27 offset:4096
  s_add_u32 m0, s68, 16384
  s_add_u32 s69, s72, 0
  buffer_load_dwordx4 v12, s[8:11], s69 offen lds
  v_mfma_f32_16x16x32_bf16 v[80:83], v[132:135], v[144:147], v[80:83]
  v_mfma_f32_16x16x32_bf16 v[84:87], v[132:135], v[148:151], v[84:87]
  ds_read_b128 v[188:191], v27 offset:6144
  v_mfma_f32_16x16x32_bf16 v[88:91], v[132:135], v[152:155], v[88:91]
  ds_read_b64_tr_b16 v[160:161], v20 offset:8192
  v_mfma_f32_16x16x32_bf16 v[92:95], v[132:135], v[156:159], v[92:95]
  ds_read_b64_tr_b16 v[162:163], v20 offset:9216
  s_add_u32 m0, s68, 17408
  s_add_u32 s69, s72, 8192
  buffer_load_dwordx4 v13, s[8:11], s69 offen lds
  v_mfma_f32_16x16x32_bf16 v[96:99], v[136:139], v[144:147], v[96:99]
  v_mfma_f32_16x16x32_bf16 v[100:103], v[136:139], v[148:151], v[100:103]
  ds_read_b64_tr_b16 v[164:165], v21 offset:8192
  v_mfma_f32_16x16x32_bf16 v[104:107], v[136:139], v[152:155], v[104:107]
  ds_read_b64_tr_b16 v[166:167], v21 offset:9216
  v_mfma_f32_16x16x32_bf16 v[108:111], v[136:139], v[156:159], v[108:111]
  ds_read_b64_tr_b16 v[168:169], v22 offset:8192
  s_add_u32 m0, s68, 18432
  s_add_u32 s69, s72, 16384
  buffer_load_dwordx4 v12, s[8:11], s69 offen lds
  v_mfma_f32_16x16x32_bf16 v[112:115], v[140:143], v[144:147], v[112:115]
  v_mfma_f32_16x16x32_bf16 v[116:119], v[140:143], v[148:151], v[116:119]
  ds_read_b64_tr_b16 v[170:171], v22 offset:9216
  v_mfma_f32_16x16x32_bf16 v[120:123], v[140:143], v[152:155], v[120:123]
  ds_read_b64_tr_b16 v[172:173], v23 offset:8192
  v_mfma_f32_16x16x32_bf16 v[124:127], v[140:143], v[156:159], v[124:127]
  ds_read_b64_tr_b16 v[174:175], v23 offset:9216
  s_add_u32 m0, s68, 19456
  s_add_u32 s69, s72, 24576
  buffer_load_dwordx4 v13, s[8:11], s69 offen lds
  s_waitcnt lgkmcnt(0)
  s_waitcnt vmcnt(8)
  s_barrier
  v_mfma_f32_16x16x32_bf16 v[64:67], v[160:163], v[176:179], v[64:67]
  v_mfma_f32_16x16x32_bf16 v[68:71], v[160:163], v[180:183], v[68:71]
  ds_read_b128 v[144:147], v26 offset:32768
  v_mfma_f32_16x16x32_bf16 v[72:75], v[160:163], v[184:187], v[72:75]
  ds_read_b128 v[148:151], v26 offset:34816
  v_mfma_f32_16x16x32_bf16 v[76:79], v[160:163], v[188:191], v[76:79]
  ds_read_b128 v[152:155], v26 offset:36864
  s_add_u32 s70, s73, 5
  s_and_b32 s70, s70, 7
  s_lshl_b32 s71, s70, 16
  s_add_u32 s71, s71, s66
  s_lshl_b32 s72, s70, 7
  s_add_u32 s72, s72, s67
  s_add_u32 m0, s68, 32768
  s_add_u32 s69, s71, 0
  buffer_load_dwordx4 v10, s[24:27], s69 offen lds
  v_mfma_f32_16x16x32_bf16 v[80:83], v[164:167], v[176:179], v[80:83]
  v_mfma_f32_16x16x32_bf16 v[84:87], v[164:167], v[180:183], v[84:87]
  ds_read_b128 v[156:159], v26 offset:38912
  v_mfma_f32_16x16x32_bf16 v[88:91], v[164:167], v[184:187], v[88:91]
  ds_read_b64_tr_b16 v[128:129], v20 offset:32768
  v_mfma_f32_16x16x32_bf16 v[92:95], v[164:167], v[188:191], v[92:95]
  ds_read_b64_tr_b16 v[130:131], v20 offset:33792
  s_add_u32 m0, s68, 33792
  s_add_u32 s69, s71, 4096
  buffer_load_dwordx4 v10, s[24:27], s69 offen lds
  v_mfma_f32_16x16x32_bf16 v[96:99], v[168:171], v[176:179], v[96:99]
  v_mfma_f32_16x16x32_bf16 v[100:103], v[168:171], v[180:183], v[100:103]
  ds_read_b64_tr_b16 v[132:133], v21 offset:32768
  v_mfma_f32_16x16x32_bf16 v[104:107], v[168:171], v[184:187], v[104:107]
  ds_read_b64_tr_b16 v[134:135], v21 offset:33792
  v_mfma_f32_16x16x32_bf16 v[108:111], v[168:171], v[188:191], v[108:111]
  ds_read_b64_tr_b16 v[136:137], v22 offset:32768
  s_add_u32 m0, s68, 34816
  s_add_u32 s69, s71, 8192
  buffer_load_dwordx4 v11, s[24:27], s69 offen lds
  v_mfma_f32_16x16x32_bf16 v[112:115], v[172:175], v[176:179], v[112:115]
  v_mfma_f32_16x16x32_bf16 v[116:119], v[172:175], v[180:183], v[116:119]
  ds_read_b64_tr_b16 v[138:139], v22 offset:33792
  v_mfma_f32_16x16x32_bf16 v[120:123], v[172:175], v[184:187], v[120:123]
  ds_read_b64_tr_b16 v[140:141], v23 offset:32768
  v_mfma_f32_16x16x32_bf16 v[124:127], v[172:175], v[188:191], v[124:127]
  ds_read_b64_tr_b16 v[142:143], v23 offset:33792
  s_add_u32 m0, s68, 35840
  s_add_u32 s69, s71, 12288
  buffer_load_dwordx4 v11, s[24:27], s69 offen lds
  s_waitcnt lgkmcnt(0)
  v_mfma_f32_16x16x32_bf16 v[64:67], v[128:131], v[144:147], v[64:67]
  v_mfma_f32_16x16x32_bf16 v[68:71], v[128:131], v[148:151], v[68:71]
  ds_read_b128 v[176:179], v27 offset:32768
  v_mfma_f32_16x16x32_bf16 v[72:75], v[128:131], v[152:155], v[72:75]
  ds_read_b128 v[180:183], v27 offset:34816
  v_mfma_f32_16x16x32_bf16 v[76:79], v[128:131], v[156:159], v[76:79]
  ds_read_b128 v[184:187], v27 offset:36864
  s_add_u32 m0, s68, 49152
  s_add_u32 s69, s72, 0
  buffer_load_dwordx4 v12, s[8:11], s69 offen lds
  v_mfma_f32_16x16x32_bf16 v[80:83], v[132:135], v[144:147], v[80:83]
  v_mfma_f32_16x16x32_bf16 v[84:87], v[132:135], v[148:151], v[84:87]
  ds_read_b128 v[188:191], v27 offset:38912
  v_mfma_f32_16x16x32_bf16 v[88:91], v[132:135], v[152:155], v[88:91]
  ds_read_b64_tr_b16 v[160:161], v20 offset:40960
  v_mfma_f32_16x16x32_bf16 v[92:95], v[132:135], v[156:159], v[92:95]
  ds_read_b64_tr_b16 v[162:163], v20 offset:41984
  s_add_u32 m0, s68, 50176
  s_add_u32 s69, s72, 8192
  buffer_load_dwordx4 v13, s[8:11], s69 offen lds
  v_mfma_f32_16x16x32_bf16 v[96:99], v[136:139], v[144:147], v[96:99]
  v_mfma_f32_16x16x32_bf16 v[100:103], v[136:139], v[148:151], v[100:103]
  ds_read_b64_tr_b16 v[164:165], v21 offset:40960
  v_mfma_f32_16x16x32_bf16 v[104:107], v[136:139], v[152:155], v[104:107]
  ds_read_b64_tr_b16 v[166:167], v21 offset:41984
  v_mfma_f32_16x16x32_bf16 v[108:111], v[136:139], v[156:159], v[108:111]
  ds_read_b64_tr_b16 v[168:169], v22 offset:40960
  s_add_u32 m0, s68, 51200
  s_add_u32 s69, s72, 16384
  buffer_load_dwordx4 v12, s[8:11], s69 offen lds
  v_mfma_f32_16x16x32_bf16 v[112:115], v[140:143], v[144:147], v[112:115]
  v_mfma_f32_16x16x32_bf16 v[116:119], v[140:143], v[148:151], v[116:119]
  ds_read_b64_tr_b16 v[170:171], v22 offset:41984
  v_mfma_f32_16x16x32_bf16 v[120:123], v[140:143], v[152:155], v[120:123]
  ds_read_b64_tr_b16 v[172:173], v23 offset:40960
  v_mfma_f32_16x16x32_bf16 v[124:127], v[140:143], v[156:159], v[124:127]
  ds_read_b64_tr_b16 v[174:175], v23 offset:41984
  s_add_u32 m0, s68, 52224
  s_add_u32 s69, s72, 24576
  buffer_load_dwordx4 v13, s[8:11], s69 offen lds
  s_waitcnt lgkmcnt(0)
  s_waitcnt vmcnt(8)
  s_barrier
  v_mfma_f32_16x16x32_bf16 v[64:67], v[160:163], v[176:179], v[64:67]
  v_mfma_f32_16x16x32_bf16 v[68:71], v[160:163], v[180:183], v[68:71]
  ds_read_b128 v[144:147], v24 offset:0
  v_mfma_f32_16x16x32_bf16 v[72:75], v[160:163], v[184:187], v[72:75]
  ds_read_b128 v[148:151], v24 offset:2048
  v_mfma_f32_16x16x32_bf16 v[76:79], v[160:163], v[188:191], v[76:79]
  ds_read_b128 v[152:155], v24 offset:4096
  s_add_u32 s70, s73, 6
  s_and_b32 s70, s70, 7
  s_lshl_b32 s71, s70, 16
  s_add_u32 s71, s71, s66
  s_lshl_b32 s72, s70, 7
  s_add_u32 s72, s72, s67
  s_add_u32 m0, s68, 65536
  s_add_u32 s69, s71, 0
  buffer_load_dwordx4 v10, s[24:27], s69 offen lds
  v_mfma_f32_16x16x32_bf16 v[80:83], v[164:167], v[176:179], v[80:83]
  v_mfma_f32_16x16x32_bf16 v[84:87], v[164:167], v[180:183], v[84:87]
  ds_read_b128 v[156:159], v24 offset:6144
  v_mfma_f32_16x16x32_bf16 v[88:91], v[164:167], v[184:187], v[88:91]
  ds_read_b64_tr_b16 v[128:129], v16 offset:0
  v_mfma_f32_16x16x32_bf16 v[92:95], v[164:167], v[188:191], v[92:95]
  ds_read_b64_tr_b16 v[130:131], v16 offset:1024
  s_add_u32 m0, s68, 66560
  s_add_u32 s69, s71, 4096
  buffer_load_dwordx4 v10, s[24:27], s69 offen lds
  v_mfma_f32_16x16x32_bf16 v[96:99], v[168:171], v[176:179], v[96:99]
  v_mfma_f32_16x16x32_bf16 v[100:103], v[168:171], v[180:183], v[100:103]
  ds_read_b64_tr_b16 v[132:133], v17 offset:0
  v_mfma_f32_16x16x32_bf16 v[104:107], v[168:171], v[184:187], v[104:107]
  ds_read_b64_tr_b16 v[134:135], v17 offset:1024
  v_mfma_f32_16x16x32_bf16 v[108:111], v[168:171], v[188:191], v[108:111]
  ds_read_b64_tr_b16 v[136:137], v18 offset:0
  s_add_u32 m0, s68, 67584
  s_add_u32 s69, s71, 8192
  buffer_load_dwordx4 v11, s[24:27], s69 offen lds
  v_mfma_f32_16x16x32_bf16 v[112:115], v[172:175], v[176:179], v[112:115]
  v_mfma_f32_16x16x32_bf16 v[116:119], v[172:175], v[180:183], v[116:119]
  ds_read_b64_tr_b16 v[138:139], v18 offset:1024
  v_mfma_f32_16x16x32_bf16 v[120:123], v[172:175], v[184:187], v[120:123]
  ds_read_b64_tr_b16 v[140:141], v19 offset:0
  v_mfma_f32_16x16x32_bf16 v[124:127], v[172:175], v[188:191], v[124:127]
  ds_read_b64_tr_b16 v[142:143], v19 offset:1024
  s_add_u32 m0, s68, 68608
  s_add_u32 s69, s71, 12288
  buffer_load_dwordx4 v11, s[24:27], s69 offen lds
  s_waitcnt lgkmcnt(0)
  v_mfma_f32_16x16x32_bf16 v[64:67], v[128:131], v[144:147], v[64:67]
  v_mfma_f32_16x16x32_bf16 v[68:71], v[128:131], v[148:151], v[68:71]
  ds_read_b128 v[176:179], v25 offset:0
  v_mfma_f32_16x16x32_bf16 v[72:75], v[128:131], v[152:155], v[72:75]
  ds_read_b128 v[180:183], v25 offset:2048
  v_mfma_f32_16x16x32_bf16 v[76:79], v[128:131], v[156:159], v[76:79]
  ds_read_b128 v[184:187], v25 offset:4096
  s_add_u32 m0, s68, 81920
  s_add_u32 s69, s72, 0
  buffer_load_dwordx4 v12, s[8:11], s69 offen lds
  v_mfma_f32_16x16x32_bf16 v[80:83], v[132:135], v[144:147], v[80:83]
  v_mfma_f32_16x16x32_bf16 v[84:87], v[132:135], v[148:151], v[84:87]
  ds_read_b128 v[188:191], v25 offset:6144
  v_mfma_f32_16x16x32_bf16 v[88:91], v[132:135], v[152:155], v[88:91]
  ds_read_b64_tr_b16 v[160:161], v16 offset:8192
  v_mfma_f32_16x16x32_bf16 v[92:95], v[132:135], v[156:159], v[92:95]
  ds_read_b64_tr_b16 v[162:163], v16 offset:9216
  s_add_u32 m0, s68, 82944
  s_add_u32 s69, s72, 8192
  buffer_load_dwordx4 v13, s[8:11], s69 offen lds
  v_mfma_f32_16x16x32_bf16 v[96:99], v[136:139], v[144:147], v[96:99]
  v_mfma_f32_16x16x32_bf16 v[100:103], v[136:139], v[148:151], v[100:103]
  ds_read_b64_tr_b16 v[164:165], v17 offset:8192
  v_mfma_f32_16x16x32_bf16 v[104:107], v[136:139], v[152:155], v[104:107]
  ds_read_b64_tr_b16 v[166:167], v17 offset:9216
  v_mfma_f32_16x16x32_bf16 v[108:111], v[136:139], v[156:159], v[108:111]
  ds_read_b64_tr_b16 v[168:169], v18 offset:8192
  s_add_u32 m0, s68, 83968
  s_add_u32 s69, s72, 16384
  buffer_load_dwordx4 v12, s[8:11], s69 offen lds
  v_mfma_f32_16x16x32_bf16 v[112:115], v[140:143], v[144:147], v[112:115]
  v_mfma_f32_16x16x32_bf16 v[116:119], v[140:143], v[148:151], v[116:119]
  ds_read_b64_tr_b16 v[170:171], v18 offset:9216
  v_mfma_f32_16x16x32_bf16 v[120:123], v[140:143], v[152:155], v[120:123]
  ds_read_b64_tr_b16 v[172:173], v19 offset:8192
  v_mfma_f32_16x16x32_bf16 v[124:127], v[140:143], v[156:159], v[124:127]
  ds_read_b64_tr_b16 v[174:175], v19 offset:9216
  s_add_u32 m0, s68, 84992
  s_add_u32 s69, s72, 24576
  buffer_load_dwordx4 v13, s[8:11], s69 offen lds
  s_waitcnt lgkmcnt(0)
  s_waitcnt vmcnt(8)
  s_barrier
  v_mfma_f32_16x16x32_bf16 v[64:67], v[160:163], v[176:179], v[64:67]
  v_mfma_f32_16x16x32_bf16 v[68:71], v[160:163], v[180:183], v[68:71]
  ds_read_b128 v[144:147], v24 offset:32768
  v_mfma_f32_16x16x32_bf16 v[72:75], v[160:163], v[184:187], v[72:75]
  ds_read_b128 v[148:151], v24 offset:34816
  v_mfma_f32_16x16x32_bf16 v[76:79], v[160:163], v[188:191], v[76:79]
  s_add_u32 s70, s73, 7
  s_and_b32 s70, s70, 7
  s_lshl_b32 s71, s70, 16
  s_add_u32 s71, s71, s66
  s_lshl_b32 s72, s70, 7
  s_add_u32 s72, s72, s67
  s_add_u32 m0, s68, 98304
  s_add_u32 s69, s71, 0
  buffer_load_dwordx4 v10, s[24:27], s69 offen lds
  ds_read_b128 v[152:155], v24 offset:36864
  v_mfma_f32_16x16x32_bf16 v[80:83], v[164:167], v[176:179], v[80:83]
  v_mfma_f32_16x16x32_bf16 v[84:87], v[164:167], v[180:183], v[84:87]
  ds_read_b128 v[156:159], v24 offset:38912
  v_mfma_f32_16x16x32_bf16 v[88:91], v[164:167], v[184:187], v[88:91]
  ds_read_b64_tr_b16 v[128:129], v16 offset:32768
  s_add_u32 m0, s68, 99328
  s_add_u32 s69, s71, 4096
  buffer_load_dwordx4 v10, s[24:27], s69 offen lds
  v_mfma_f32_16x16x32_bf16 v[92:95], v[164:167], v[188:191], v[92:95]
  ds_read_b64_tr_b16 v[130:131], v16 offset:33792
  v_mfma_f32_16x16x32_bf16 v[96:99], v[168:171], v[176:179], v[96:99]
  v_mfma_f32_16x16x32_bf16 v[100:103], v[168:171], v[180:183], v[100:103]
  ds_read_b64_tr_b16 v[132:133], v17 offset:32768
  s_add_u32 m0, s68, 100352
  s_add_u32 s69, s71, 8192
  buffer_load_dwordx4 v11, s[24:27], s69 offen lds
  v_mfma_f32_16x16x32_bf16 v[104:107], v[168:171], v[184:187], v[104:107]
  ds_read_b64_tr_b16 v[134:135], v17 offset:33792
  v_mfma_f32_16x16x32_bf16 v[108:111], v[168:171], v[188:191], v[108:111]
  ds_read_b64_tr_b16 v[136:137], v18 offset:32768
  v_mfma_f32_16x16x32_bf16 v[112:115], v[172:175], v[176:179], v[112:115]
  v_mfma_f32_16x16x32_bf16 v[116:119], v[172:175], v[180:183], v[116:119]
  s_add_u32 m0, s68, 101376
  s_add_u32 s69, s71, 12288
  buffer_load_dwordx4 v11, s[24:27], s69 offen lds
  ds_read_b64_tr_b16 v[138:139], v18 offset:33792
  v_mfma_f32_16x16x32_bf16 v[120:123], v[172:175], v[184:187], v[120:123]
  ds_read_b64_tr_b16 v[140:141], v19 offset:32768
  v_mfma_f32_16x16x32_bf16 v[124:127], v[172:175], v[188:191], v[124:127]
  ds_read_b64_tr_b16 v[142:143], v19 offset:33792
  buffer_load_dword v28, off, s[52:55], 0 sc1
  s_waitcnt lgkmcnt(0)
  v_mfma_f32_16x16x32_bf16 v[64:67], v[128:131], v[144:147], v[64:67]
  v_mfma_f32_16x16x32_bf16 v[68:71], v[128:131], v[148:151], v[68:71]
  ds_read_b128 v[176:179], v25 offset:32768
  v_mfma_f32_16x16x32_bf16 v[72:75], v[128:131], v[152:155], v[72:75]
  ds_read_b128 v[180:183], v25 offset:34816
  v_mfma_f32_16x16x32_bf16 v[76:79], v[128:131], v[156:159], v[76:79]
  ds_read_b128 v[184:187], v25 offset:36864
  s_add_u32 m0, s68, 114688
  s_add_u32 s69, s72, 0
  buffer_load_dwordx4 v12, s[8:11], s69 offen lds
  v_mfma_f32_16x16x32_bf16 v[80:83], v[132:135], v[144:147], v[80:83]
  v_mfma_f32_16x16x32_bf16 v[84:87], v[132:135], v[148:151], v[84:87]
  ds_read_b128 v[188:191], v25 offset:38912
  v_mfma_f32_16x16x32_bf16 v[88:91], v[132:135], v[152:155], v[88:91]
  ds_read_b64_tr_b16 v[160:161], v16 offset:40960
  v_mfma_f32_16x16x32_bf16 v[92:95], v[132:135], v[156:159], v[92:95]
  ds_read_b64_tr_b16 v[162:163], v16 offset:41984
  s_add_u32 m0, s68, 115712
  s_add_u32 s69, s72, 8192
  buffer_load_dwordx4 v13, s[8:11], s69 offen lds
  v_mfma_f32_16x16x32_bf16 v[96:99], v[136:139], v[144:147], v[96:99]
  v_mfma_f32_16x16x32_bf16 v[100:103], v[136:139], v[148:151], v[100:103]
  ds_read_b64_tr_b16 v[164:165], v17 offset:40960
  v_mfma_f32_16x16x32_bf16 v[104:107], v[136:139], v[152:155], v[104:107]
  ds_read_b64_tr_b16 v[166:167], v17 offset:41984
  v_mfma_f32_16x16x32_bf16 v[108:111], v[136:139], v[156:159], v[108:111]
  ds_read_b64_tr_b16 v[168:169], v18 offset:40960
  s_add_u32 m0, s68, 116736
  s_add_u32 s69, s72, 16384
  buffer_load_dwordx4 v12, s[8:11], s69 offen lds
  v_mfma_f32_16x16x32_bf16 v[112:115], v[140:143], v[144:147], v[112:115]
  v_mfma_f32_16x16x32_bf16 v[116:119], v[140:143], v[148:151], v[116:119]
  ds_read_b64_tr_b16 v[170:171], v18 offset:41984
  v_mfma_f32_16x16x32_bf16 v[120:123], v[140:143], v[152:155], v[120:123]
  ds_read_b64_tr_b16 v[172:173], v19 offset:40960
  v_mfma_f32_16x16x32_bf16 v[124:127], v[140:143], v[156:159], v[124:127]
  ds_read_b64_tr_b16 v[174:175], v19 offset:41984
  s_add_u32 m0, s68, 117760
  s_add_u32 s69, s72, 24576
  buffer_load_dwordx4 v13, s[8:11], s69 offen lds
  s_waitcnt lgkmcnt(0)
  s_waitcnt vmcnt(9)
  s_barrier
  v_mfma_f32_16x16x32_bf16 v[64:67], v[160:163], v[176:179], v[64:67]
  v_mfma_f32_16x16x32_bf16 v[68:71], v[160:163], v[180:183], v[68:71]
  ds_read_b128 v[144:147], v26 offset:0
  v_mfma_f32_16x16x32_bf16 v[72:75], v[160:163], v[184:187], v[72:75]
  ds_read_b128 v[148:151], v26 offset:2048
  v_mfma_f32_16x16x32_bf16 v[76:79], v[160:163], v[188:191], v[76:79]
  ds_read_b128 v[152:155], v26 offset:4096
  v_mfma_f32_16x16x32_bf16 v[80:83], v[164:167], v[176:179], v[80:83]
  v_mfma_f32_16x16x32_bf16 v[84:87], v[164:167], v[180:183], v[84:87]
  ds_read_b128 v[156:159], v26 offset:6144
  v_mfma_f32_16x16x32_bf16 v[88:91], v[164:167], v[184:187], v[88:91]
  ds_read_b64_tr_b16 v[128:129], v20 offset:0
  v_mfma_f32_16x16x32_bf16 v[92:95], v[164:167], v[188:191], v[92:95]
  ds_read_b64_tr_b16 v[130:131], v20 offset:1024
  v_mfma_f32_16x16x32_bf16 v[96:99], v[168:171], v[176:179], v[96:99]
  v_mfma_f32_16x16x32_bf16 v[100:103], v[168:171], v[180:183], v[100:103]
  ds_read_b64_tr_b16 v[132:133], v21 offset:0
  v_mfma_f32_16x16x32_bf16 v[104:107], v[168:171], v[184:187], v[104:107]
  ds_read_b64_tr_b16 v[134:135], v21 offset:1024
  v_mfma_f32_16x16x32_bf16 v[108:111], v[168:171], v[188:191], v[108:111]
  ds_read_b64_tr_b16 v[136:137], v22 offset:0
  v_mfma_f32_16x16x32_bf16 v[112:115], v[172:175], v[176:179], v[112:115]
  v_mfma_f32_16x16x32_bf16 v[116:119], v[172:175], v[180:183], v[116:119]
  ds_read_b64_tr_b16 v[138:139], v22 offset:1024
  v_mfma_f32_16x16x32_bf16 v[120:123], v[172:175], v[184:187], v[120:123]
  ds_read_b64_tr_b16 v[140:141], v23 offset:0
  v_mfma_f32_16x16x32_bf16 v[124:127], v[172:175], v[188:191], v[124:127]
  ds_read_b64_tr_b16 v[142:143], v23 offset:1024
  s_waitcnt lgkmcnt(0)
  v_mfma_f32_16x16x32_bf16 v[64:67], v[128:131], v[144:147], v[64:67]
  v_mfma_f32_16x16x32_bf16 v[68:71], v[128:131], v[148:151], v[68:71]
  ds_read_b128 v[176:179], v27 offset:0
  v_mfma_f32_16x16x32_bf16 v[72:75], v[128:131], v[152:155], v[72:75]
  ds_read_b128 v[180:183], v27 offset:2048
  v_mfma_f32_16x16x32_bf16 v[76:79], v[128:131], v[156:159], v[76:79]
  ds_read_b128 v[184:187], v27 offset:4096
  v_mfma_f32_16x16x32_bf16 v[80:83], v[132:135], v[144:147], v[80:83]
  v_mfma_f32_16x16x32_bf16 v[84:87], v[132:135], v[148:151], v[84:87]
  ds_read_b128 v[188:191], v27 offset:6144
  v_mfma_f32_16x16x32_bf16 v[88:91], v[132:135], v[152:155], v[88:91]
  ds_read_b64_tr_b16 v[160:161], v20 offset:8192
  v_mfma_f32_16x16x32_bf16 v[92:95], v[132:135], v[156:159], v[92:95]
  ds_read_b64_tr_b16 v[162:163], v20 offset:9216
  v_mfma_f32_16x16x32_bf16 v[96:99], v[136:139], v[144:147], v[96:99]
  v_mfma_f32_16x16x32_bf16 v[100:103], v[136:139], v[148:151], v[100:103]
  ds_read_b64_tr_b16 v[164:165], v21 offset:8192
  v_mfma_f32_16x16x32_bf16 v[104:107], v[136:139], v[152:155], v[104:107]
  ds_read_b64_tr_b16 v[166:167], v21 offset:9216
  v_mfma_f32_16x16x32_bf16 v[108:111], v[136:139], v[156:159], v[108:111]
  ds_read_b64_tr_b16 v[168:169], v22 offset:8192
  v_mfma_f32_16x16x32_bf16 v[112:115], v[140:143], v[144:147], v[112:115]
  v_mfma_f32_16x16x32_bf16 v[116:119], v[140:143], v[148:151], v[116:119]
  ds_read_b64_tr_b16 v[170:171], v22 offset:9216
  v_mfma_f32_16x16x32_bf16 v[120:123], v[140:143], v[152:155], v[120:123]
  ds_read_b64_tr_b16 v[172:173], v23 offset:8192
  v_mfma_f32_16x16x32_bf16 v[124:127], v[140:143], v[156:159], v[124:127]
  ds_read_b64_tr_b16 v[174:175], v23 offset:9216
  s_waitcnt lgkmcnt(0)
  s_waitcnt vmcnt(0)
  s_barrier
  v_mfma_f32_16x16x32_bf16 v[64:67], v[160:163], v[176:179], v[64:67]
  v_mfma_f32_16x16x32_bf16 v[68:71], v[160:163], v[180:183], v[68:71]
  ds_read_b128 v[144:147], v26 offset:32768
  v_mfma_f32_16x16x32_bf16 v[72:75], v[160:163], v[184:187], v[72:75]
  ds_read_b128 v[148:151], v26 offset:34816
  v_mfma_f32_16x16x32_bf16 v[76:79], v[160:163], v[188:191], v[76:79]
  ds_read_b128 v[152:155], v26 offset:36864
  v_mfma_f32_16x16x32_bf16 v[80:83], v[164:167], v[176:179], v[80:83]
  v_mfma_f32_16x16x32_bf16 v[84:87], v[164:167], v[180:183], v[84:87]
  ds_read_b128 v[156:159], v26 offset:38912
  v_mfma_f32_16x16x32_bf16 v[88:91], v[164:167], v[184:187], v[88:91]
  ds_read_b64_tr_b16 v[128:129], v20 offset:32768
  v_mfma_f32_16x16x32_bf16 v[92:95], v[164:167], v[188:191], v[92:95]
  ds_read_b64_tr_b16 v[130:131], v20 offset:33792
  v_mfma_f32_16x16x32_bf16 v[96:99], v[168:171], v[176:179], v[96:99]
  v_mfma_f32_16x16x32_bf16 v[100:103], v[168:171], v[180:183], v[100:103]
  ds_read_b64_tr_b16 v[132:133], v21 offset:32768
  v_mfma_f32_16x16x32_bf16 v[104:107], v[168:171], v[184:187], v[104:107]
  ds_read_b64_tr_b16 v[134:135], v21 offset:33792
  v_mfma_f32_16x16x32_bf16 v[108:111], v[168:171], v[188:191], v[108:111]
  ds_read_b64_tr_b16 v[136:137], v22 offset:32768
  v_mfma_f32_16x16x32_bf16 v[112:115], v[172:175], v[176:179], v[112:115]
  v_mfma_f32_16x16x32_bf16 v[116:119], v[172:175], v[180:183], v[116:119]
  ds_read_b64_tr_b16 v[138:139], v22 offset:33792
  v_mfma_f32_16x16x32_bf16 v[120:123], v[172:175], v[184:187], v[120:123]
  ds_read_b64_tr_b16 v[140:141], v23 offset:32768
  v_mfma_f32_16x16x32_bf16 v[124:127], v[172:175], v[188:191], v[124:127]
  ds_read_b64_tr_b16 v[142:143], v23 offset:33792
  s_waitcnt lgkmcnt(0)
  v_mfma_f32_16x16x32_bf16 v[64:67], v[128:131], v[144:147], v[64:67]
  v_mfma_f32_16x16x32_bf16 v[68:71], v[128:131], v[148:151], v[68:71]
  ds_read_b128 v[176:179], v27 offset:32768
  v_mfma_f32_16x16x32_bf16 v[72:75], v[128:131], v[152:155], v[72:75]
  ds_read_b128 v[180:183], v27 offset:34816
  v_mfma_f32_16x16x32_bf16 v[76:79], v[128:131], v[156:159], v[76:79]
  ds_read_b128 v[184:187], v27 offset:36864
  v_mfma_f32_16x16x32_bf16 v[80:83], v[132:135], v[144:147], v[80:83]
  v_mfma_f32_16x16x32_bf16 v[84:87], v[132:135], v[148:151], v[84:87]
  ds_read_b128 v[188:191], v27 offset:38912
  v_mfma_f32_16x16x32_bf16 v[88:91], v[132:135], v[152:155], v[88:91]
  ds_read_b64_tr_b16 v[160:161], v20 offset:40960
  v_mfma_f32_16x16x32_bf16 v[92:95], v[132:135], v[156:159], v[92:95]
  ds_read_b64_tr_b16 v[162:163], v20 offset:41984
  v_mfma_f32_16x16x32_bf16 v[96:99], v[136:139], v[144:147], v[96:99]
  v_mfma_f32_16x16x32_bf16 v[100:103], v[136:139], v[148:151], v[100:103]
  ds_read_b64_tr_b16 v[164:165], v21 offset:40960
  v_mfma_f32_16x16x32_bf16 v[104:107], v[136:139], v[152:155], v[104:107]
  ds_read_b64_tr_b16 v[166:167], v21 offset:41984
  v_mfma_f32_16x16x32_bf16 v[108:111], v[136:139], v[156:159], v[108:111]
  ds_read_b64_tr_b16 v[168:169], v22 offset:40960
  v_mfma_f32_16x16x32_bf16 v[112:115], v[140:143], v[144:147], v[112:115]
  v_mfma_f32_16x16x32_bf16 v[116:119], v[140:143], v[148:151], v[116:119]
  ds_read_b64_tr_b16 v[170:171], v22 offset:41984
  v_mfma_f32_16x16x32_bf16 v[120:123], v[140:143], v[152:155], v[120:123]
  ds_read_b64_tr_b16 v[172:173], v23 offset:40960
  v_mfma_f32_16x16x32_bf16 v[124:127], v[140:143], v[156:159], v[124:127]
  ds_read_b64_tr_b16 v[174:175], v23 offset:41984
  s_waitcnt lgkmcnt(0)
  v_mfma_f32_16x16x32_bf16 v[64:67], v[160:163], v[176:179], v[64:67]
  v_mfma_f32_16x16x32_bf16 v[68:71], v[160:163], v[180:183], v[68:71]
  v_mfma_f32_16x16x32_bf16 v[72:75], v[160:163], v[184:187], v[72:75]
  v_mfma_f32_16x16x32_bf16 v[76:79], v[160:163], v[188:191], v[76:79]
  v_mfma_f32_16x16x32_bf16 v[80:83], v[164:167], v[176:179], v[80:83]
  v_mfma_f32_16x16x32_bf16 v[84:87], v[164:167], v[180:183], v[84:87]
  v_mfma_f32_16x16x32_bf16 v[88:91], v[164:167], v[184:187], v[88:91]
  v_mfma_f32_16x16x32_bf16 v[92:95], v[164:167], v[188:191], v[92:95]
  v_mfma_f32_16x16x32_bf16 v[96:99], v[168:171], v[176:179], v[96:99]
  v_mfma_f32_16x16x32_bf16 v[100:103], v[168:171], v[180:183], v[100:103]
  v_mfma_f32_16x16x32_bf16 v[104:107], v[168:171], v[184:187], v[104:107]
  v_mfma_f32_16x16x32_bf16 v[108:111], v[168:171], v[188:191], v[108:111]
  v_mfma_f32_16x16x32_bf16 v[112:115], v[172:175], v[176:179], v[112:115]
  v_mfma_f32_16x16x32_bf16 v[116:119], v[172:175], v[180:183], v[116:119]
  v_mfma_f32_16x16x32_bf16 v[120:123], v[172:175], v[184:187], v[120:123]
  v_mfma_f32_16x16x32_bf16 v[124:127], v[172:175], v[188:191], v[124:127]
  s_nop 7
  s_nop 1
  v_lshlrev_b32 v1, 4, v0
  s_lshl_b32 s70, s59, 7
  s_lshl_b32 s71, s65, 6
  s_add_u32 s70, s70, s71
  s_lshl_b32 s71, s58, 2
  s_add_u32 s70, s70, s71
  s_lshl_b32 s71, s64, 1
  s_add_u32 s70, s70, s71
  s_lshl_b32 s70, s70, 10
  s_add_u32 s71, s70, 0
  v_cvt_pk_bf16_f32 v128, v64, v65
  v_cvt_pk_bf16_f32 v129, v66, v67
  v_cvt_pk_bf16_f32 v130, v80, v81
  v_cvt_pk_bf16_f32 v131, v82, v83
  buffer_store_dwordx4 v[128:131], v1, s[40:43], s71 offen offset:0 sc1
  v_cvt_pk_bf16_f32 v132, v96, v97
  v_cvt_pk_bf16_f32 v133, v98, v99
  v_cvt_pk_bf16_f32 v134, v112, v113
  v_cvt_pk_bf16_f32 v135, v114, v115
  buffer_store_dwordx4 v[132:135], v1, s[40:43], s71 offen offset:1024 sc1
  s_add_u32 s71, s70, 16384
  v_cvt_pk_bf16_f32 v136, v68, v69
  v_cvt_pk_bf16_f32 v137, v70, v71
  v_cvt_pk_bf16_f32 v138, v84, v85
  v_cvt_pk_bf16_f32 v139, v86, v87
  buffer_store_dwordx4 v[136:139], v1, s[40:43], s71 offen offset:0 sc1
  v_cvt_pk_bf16_f32 v140, v100, v101
  v_cvt_pk_bf16_f32 v141, v102, v103
  v_cvt_pk_bf16_f32 v142, v116, v117
  v_cvt_pk_bf16_f32 v143, v118, v119
  buffer_store_dwordx4 v[140:143], v1, s[40:43], s71 offen offset:1024 sc1
  s_add_u32 s71, s70, 32768
  v_cvt_pk_bf16_f32 v144, v72, v73
  v_cvt_pk_bf16_f32 v145, v74, v75
  v_cvt_pk_bf16_f32 v146, v88, v89
  v_cvt_pk_bf16_f32 v147, v90, v91
  buffer_store_dwordx4 v[144:147], v1, s[40:43], s71 offen offset:0 sc1
  v_cvt_pk_bf16_f32 v148, v104, v105
  v_cvt_pk_bf16_f32 v149, v106, v107
  v_cvt_pk_bf16_f32 v150, v120, v121
  v_cvt_pk_bf16_f32 v151, v122, v123
  buffer_store_dwordx4 v[148:151], v1, s[40:43], s71 offen offset:1024 sc1
  s_add_u32 s71, s70, 49152
  v_cvt_pk_bf16_f32 v152, v76, v77
  v_cvt_pk_bf16_f32 v153, v78, v79
  v_cvt_pk_bf16_f32 v154, v92, v93
  v_cvt_pk_bf16_f32 v155, v94, v95
  buffer_store_dwordx4 v[152:155], v1, s[40:43], s71 offen offset:0 sc1
  v_cvt_pk_bf16_f32 v156, v108, v109
  v_cvt_pk_bf16_f32 v157, v110, v111
  v_cvt_pk_bf16_f32 v158, v124, v125
  v_cvt_pk_bf16_f32 v159, v126, v127
  buffer_store_dwordx4 v[156:159], v1, s[40:43], s71 offen offset:1024 sc1
  s_waitcnt vmcnt(0)
  v_readfirstlane_b32 s57, v28
  s_mov_b32 s62, 200000
NC_16:
  s_cmp_lg_u32 s57, 0
  s_cbranch_scc1 ND_17
  s_sub_u32 s62, s62, 1
  s_cbranch_scc1 ND_17
  s_sleep 2
  buffer_load_dword v28, off, s[52:55], 0 sc1
  s_waitcnt vmcnt(0)
  v_readfirstlane_b32 s57, v28
  s_branch NC_16
ND_17:
  s_lshl_b32 s70, s59, 7
  s_lshl_b32 s71, s58, 2
  s_add_u32 s70, s70, s71
  s_add_u32 s70, s70, 8192
  s_barrier
  s_cmp_eq_u32 s56, 0
  s_cbranch_scc0 WF_18
  v_mov_b32 v2, s57
  s_mov_b64 exec, 1
  buffer_store_dword v2, off, s[48:51], s70 sc1
  s_mov_b64 exec, -1
WF_18:
  s_branch K_pre
K_spare:
  s_waitcnt lgkmcnt(0)
  s_add_u32 s36, s92, 0
  s_addc_u32 s37, s93, 0
  s_add_u32 s48, s92, 6291456
  s_addc_u32 s49, s93, 0
  s_add_u32 s40, s92, 2097152
  s_addc_u32 s41, s93, 0
  s_add_u32 s44, s92, 4194304
  s_addc_u32 s45, s93, 0
  buffer_load_dword v9, off, s[52:55], 0 sc1
  s_waitcnt vmcnt(0)
  v_readfirstlane_b32 s57, v9
  s_mov_b32 s62, 200000
NC_19:
  s_cmp_lg_u32 s57, 0
  s_cbranch_scc1 ND_20
  s_sub_u32 s62, s62, 1
  s_cbranch_scc1 ND_20
  s_sleep 2
  buffer_load_dword v9, off, s[52:55], 0 sc1
  s_waitcnt vmcnt(0)
  v_readfirstlane_b32 s57, v9
  s_branch NC_19
ND_20:
K_pre:
  s_cmp_ge_u32 s61, 15
  s_cbranch_scc1 K_fin
  v_and_b32 v18, 3, v0
  v_lshlrev_b32 v18, 2, v18
  s_lshl_b32 s67, s60, 7
  s_add_u32 s67, s67, 8192
  s_nop 0
  s_cmp_eq_u32 s56, 0
  s_cbranch_scc0 PS_23
  s_mov_b32 s62, 200000
PL_21:
  buffer_load_dword v19, v18, s[48:51], s67 offen sc1
  s_waitcnt vmcnt(0)
  v_cmp_ne_u32 s[64:65], s57, v19
  s_cmp_eq_u64 s[64:65], 0
  s_cbranch_scc1 PD_22
  s_sub_u32 s62, s62, 1
  s_cbranch_scc1 PD_22
  s_sleep 8
  s_branch PL_21
PD_22:
PS_23:
  s_barrier
  s_cmp_ge_u32 s61, 15
  s_cbranch_scc1 YX_24
  s_and_b32 s74, s60, 3
  s_lshl_b32 s74, s74, 2
  s_and_b32 s75, s61, 7
  s_lshl_b32 s75, s75, 1
  s_add_u32 s74, s74, s75
  v_lshlrev_b32 v10, 4, v0
  s_lshl_b32 s69, s60, 17
  s_lshl_b32 s75, s56, 15
  s_add_u32 s69, s69, s75
  s_add_u32 s75, s74, 0
  s_and_b32 s75, s75, 15
  s_lshl_b32 s75, s75, 10
  s_add_u32 s75, s75, s69
  buffer_load_dwordx4 a[0:3], v10, s[40:43], s75 offen sc1
  s_add_u32 s75, s75, 16384
  buffer_load_dwordx4 a[4:7], v10, s[40:43], s75 offen sc1
  s_add_u32 s75, s74, 1
  s_and_b32 s75, s75, 15
  s_lshl_b32 s75, s75, 10
  s_add_u32 s75, s75, s69
  buffer_load_dwordx4 a[8:11], v10, s[40:43], s75 offen sc1
  s_add_u32 s75, s75, 16384
  buffer_load_dwordx4 a[12:15], v10, s[40:43], s75 offen sc1
  s_add_u32 s75, s74, 2
  s_and_b32 s75, s75, 15
  s_lshl_b32 s75, s75, 10
  s_add_u32 s75, s75, s69
  buffer_load_dwordx4 a[16:19], v10, s[40:43], s75 offen sc1
  s_add_u32 s75, s75, 16384
  buffer_load_dwordx4 a[20:23], v10, s[40:43], s75 offen sc1
  s_add_u32 s75, s74, 3
  s_and_b32 s75, s75, 15
  s_lshl_b32 s75, s75, 10
  s_add_u32 s75, s75, s69
  buffer_load_dwordx4 a[24:27], v10, s[40:43], s75 offen sc1
  s_add_u32 s75, s75, 16384
  buffer_load_dwordx4 a[28:31], v10, s[40:43], s75 offen sc1
  s_add_u32 s75, s74, 4
  s_and_b32 s75, s75, 15
  s_lshl_b32 s75, s75, 10
  s_add_u32 s75, s75, s69
  buffer_load_dwordx4 a[32:35], v10, s[40:43], s75 offen sc1
  s_add_u32 s75, s75, 16384
  buffer_load_dwordx4 a[36:39], v10, s[40:43], s75 offen sc1
  s_add_u32 s75, s74, 5
  s_and_b32 s75, s75, 15
  s_lshl_b32 s75, s75, 10
  s_add_u32 s75, s75, s69
  buffer_load_dwordx4 a[40:43], v10, s[40:43], s75 offen sc1
  s_add_u32 s75, s75, 16384
  buffer_load_dwordx4 a[44:47], v10, s[40:43], s75 offen sc1
  s_add_u32 s75, s74, 6
  s_and_b32 s75, s75, 15
  s_lshl_b32 s75, s75, 10
  s_add_u32 s75, s75, s69
  buffer_load_dwordx4 a[48:51], v10, s[40:43], s75 offen sc1
  s_add_u32 s75, s75, 16384
  buffer_load_dwordx4 a[52:55], v10, s[40:43], s75 offen sc1
  s_add_u32 s75, s74, 7
  s_and_b32 s75, s75, 15
  s_lshl_b32 s75, s75, 10
  s_add_u32 s75, s75, s69
  buffer_load_dwordx4 a[56:59], v10, s[40:43], s75 offen sc1
  s_add_u32 s75, s75, 16384
  buffer_load_dwordx4 a[60:63], v10, s[40:43], s75 offen sc1
  s_add_u32 s75, s74, 8
  s_and_b32 s75, s75, 15
  s_lshl_b32 s75, s75, 10
  s_add_u32 s75, s75, s69
  buffer_load_dwordx4 a[64:67], v10, s[40:43], s75 offen sc1
  s_add_u32 s75, s75, 16384
  buffer_load_dwordx4 a[68:71], v10, s[40:43], s75 offen sc1
  s_add_u32 s75, s74, 9
  s_and_b32 s75, s75, 15
  s_lshl_b32 s75, s75, 10
  s_add_u32 s75, s75, s69
  buffer_load_dwordx4 a[72:75], v10, s[40:43], s75 offen sc1
  s_add_u32 s75, s75, 16384
  buffer_load_dwordx4 a[76:79], v10, s[40:43], s75 offen sc1
  s_add_u32 s75, s74, 10
  s_and_b32 s75, s75, 15
  s_lshl_b32 s75, s75, 10
  s_add_u32 s75, s75, s69
  buffer_load_dwordx4 a[80:83], v10, s[40:43], s75 offen sc1
  s_add_u32 s75, s75, 16384
  buffer_load_dwordx4 a[84:87], v10, s[40:43], s75 offen sc1
  s_add_u32 s75, s74, 11
  s_and_b32 s75, s75, 15
  s_lshl_b32 s75, s75, 10
  s_add_u32 s75, s75, s69
  buffer_load_dwordx4 a[88:91], v10, s[40:43], s75 offen sc1
  s_add_u32 s75, s75, 16384
  buffer_load_dwordx4 a[92:95], v10, s[40:43], s75 offen sc1
  s_add_u32 s75, s74, 12
  s_and_b32 s75, s75, 15
  s_lshl_b32 s75, s75, 10
  s_add_u32 s75, s75, s69
  buffer_load_dwordx4 a[96:99], v10, s[40:43], s75 offen sc1
  s_add_u32 s75, s75, 16384
  buffer_load_dwordx4 a[100:103], v10, s[40:43], s75 offen sc1
  s_add_u32 s75, s74, 13
  s_and_b32 s75, s75, 15
  s_lshl_b32 s75, s75, 10
  s_add_u32 s75, s75, s69
  buffer_load_dwordx4 a[104:107], v10, s[40:43], s75 offen sc1
  s_add_u32 s75, s75, 16384
  buffer_load_dwordx4 a[108:111], v10, s[40:43], s75 offen sc1
  s_add_u32 s75, s74, 14
  s_and_b32 s75, s75, 15
  s_lshl_b32 s75, s75, 10
  s_add_u32 s75, s75, s69
  buffer_load_dwordx4 a[112:115], v10, s[40:43], s75 offen sc1
  s_add_u32 s75, s75, 16384
  buffer_load_dwordx4 a[116:119], v10, s[40:43], s75 offen sc1
  s_add_u32 s75, s74, 15
  s_and_b32 s75, s75, 15
  s_lshl_b32 s75, s75, 10
  s_add_u32 s75, s75, s69
  buffer_load_dwordx4 a[120:123], v10, s[40:43], s75 offen sc1
  s_add_u32 s75, s75, 16384
  buffer_load_dwordx4 a[124:127], v10, s[40:43], s75 offen sc1
YX_24:
  v_and_b32 v12, 7, v0
  v_lshlrev_b32 v12, 2, v12
  v_bfe_u32 v13, v0, 3, 1
  s_cmp_eq_u32 s61, 14
  s_cselect_b32 s63, 0, 128
  v_mul_u32_u24 v13, s63, v13
  v_add_u32 v12, v12, v13
  s_min_u32 s68, s61, 14
  s_mul_i32 s68, s68, 3
  s_lshr_b32 s68, s68, 1
  s_lshl_b32 s68, s68, 7
  s_add_u32 s68, s68, 4096
  s_cmp_eq_u32 s56, 0
  s_cbranch_scc0 PS_27
  s_mov_b32 s62, 200000
PL_25:
  buffer_load_dword v14, v12, s[48:51], s68 offen sc1
  s_waitcnt vmcnt(0)
  v_cmp_ne_u32 s[64:65], s57, v14
  s_cmp_eq_u64 s[64:65], 0
  s_cbranch_scc1 PD_26
  s_sub_u32 s62, s62, 1
  s_cbranch_scc1 PD_26
  s_sleep 4
  s_branch PL_25
PD_26:
PS_27:
  s_barrier
  v_mov_b32 v14, s57
  s_branch K_y
K_code_end:
.section .rodata,"a"
.p2align 6
.amdhsa_kernel standalone__weight_only_int_quip__prompt_kernel
  .amdhsa_next_free_vgpr 512
  .amdhsa_next_free_sgpr 102
  .amdhsa_accum_offset 256
  .amdhsa_group_segment_fixed_size 0
  .amdhsa_kernarg_size 72
  .amdhsa_user_sgpr_count 2
  .amdhsa_user_sgpr_kernarg_segment_ptr 1
  .amdhsa_system_sgpr_workgroup_id_x 1
.end_amdhsa_kernel
```
